```python
import torch

def _softmax(x, axis=-1):
    return torch.softmax(x, dim=axis)
def _gelu(x):
    return torch.nn.functional.gelu(x, approximate="tanh")
def _silu(x):
    return torch.nn.functional.silu(x)
def _sigmoid(x):
    return torch.sigmoid(x)
def _layernorm(x, axis=-1, eps=1e-5):
    m = x.mean(dim=axis, keepdim=True)
    v = x.var(dim=axis, keepdim=True, unbiased=False)
    return (x - m) / torch.sqrt(v + eps)
def _scatter_add(tgt, idx, src, axis=0):
    return tgt.clone().index_add_(axis, idx, src)
def _segment_sum(src, seg, n):
    out = torch.zeros((n,) + src.shape[1:], dtype=src.dtype)
    return out.index_add_(0, seg, src)
def _pad(x, pw):
    flat = tuple(v for pair in reversed(pw) for v in pair)
    return torch.nn.functional.pad(x, flat)

kernel_name = 'sequential_preLN__softmax_full_mha__dense_activation_mish__prompt'

def setup_inputs():

    _w = (lambda a: (lambda t: t.to(torch.bfloat16) if t.is_floating_point() else t)(torch.as_tensor(a)))
    def _A_setup():
        B, S, D = 1, 2048, 512
        return {
            "x": _w((lambda *s: torch.randn(*s, dtype=torch.bfloat16) * 0.05)(B, S, D)),
            "wqkv": _w((lambda *s: torch.randn(*s, dtype=torch.bfloat16) * 0.05)(D, 3 * D)),
            "wo": _w((lambda *s: torch.randn(*s, dtype=torch.bfloat16) * 0.05)(D, D)),
        }
    _A_in = _A_setup()

    def _B_setup():
        B, S, D, F = 1, 2048, 512, 1792
        return {
            "x": _w((lambda *s: torch.randn(*s, dtype=torch.bfloat16) * 0.05)(B, S, D)),
            "w1": _w((lambda *s: torch.randn(*s, dtype=torch.bfloat16) * 0.8)(D, F) * (D ** -0.5)),
            "b1": _w((lambda *s: torch.randn(*s, dtype=torch.bfloat16) * 0.4)(F)),
            "w2": _w((lambda *s: torch.randn(*s, dtype=torch.bfloat16) * 0.2)(F, D) * (F ** -0.5)),
        }
    _B_in = _B_setup()

    return {
        "A_x": _A_in["x"],
        "A_wqkv": _A_in["wqkv"],
        "A_wo": _A_in["wo"],
        "B_x": _B_in["x"],
        "B_w1": _B_in["w1"],
        "B_b1": _B_in["b1"],
        "B_w2": _B_in["w2"],
    }

def reference(A_x, A_wqkv, A_wo, B_x, B_w1, B_b1, B_w2):
    def _A_ref(x, wqkv, wo):
        B, S, D = x.shape
        H = 32; Dh = D // H
        qkv = (lambda x, *d: x.permute(*d))((x @ wqkv).reshape(B, S, 3, H, Dh), 2, 0, 3, 1, 4)
        q, k, v = qkv[0], qkv[1], qkv[2]
        scale = Dh ** -0.5
        scores = torch.einsum("bhqd,bhkd->bhqk", q, k) * scale
        p = _softmax(scores, axis=-1)
        o = torch.einsum("bhqk,bhkd->bhqd", p, v)
        return (lambda x, *d: x.permute(*d))(o, 0, 2, 1, 3).reshape(B, S, D) @ wo

    def _B_ref(x, w1, b1, w2):
        h = torch.einsum("bsd,df->bsf", x, w1) + b1
        sp = torch.log1p(torch.exp(-torch.abs(h))) + torch.where(h > 0, h, torch.zeros_like(h))
        act = h * torch.tanh(sp)
        return torch.einsum("bsf,fd->bsd", act, w2)

    x = A_x
    h = x + _A_ref(_layernorm(x, axis=-1), A_wqkv, A_wo)
    h2 = h + _B_ref(_layernorm(h, axis=-1), B_w1, B_b1, B_w2)
    return h2
```

```asm
; @launch kernel=k1_qkv_kernel grid=(256,1,1) block=(768,1,1) lds=163840
; @launch kernel=k2_main_kernel grid=(256,1,1) block=(768,1,1) lds=163840
.amdgcn_target "amdgcn-amd-amdhsa--gfx950"
.text
.globl k1_qkv_kernel
.p2align 8
.type k1_qkv_kernel,@function
k1_qkv_kernel:
    s_cmp_ge_u32 s2, 256
    s_cbranch_scc1 k1_qkv_kernel_end
    s_load_dwordx4 s[4:7], s[0:1], 0
    s_load_dwordx2 s[8:9], s[0:1], 72
    v_lshrrev_b32 v1, 6, v0
    v_and_b32 v0, 63, v0
    v_readfirstlane_b32 s24, v1
    s_and_b32 s44, s2, 7
    s_lshr_b32 s45, s2, 3
    s_and_b32 s46, s44, 3
    s_lshl_b32 s46, s46, 3
    s_and_b32 s47, s45, 7
    s_add_u32 s25, s46, s47
    s_lshr_b32 s46, s44, 2
    s_lshl_b32 s46, s46, 2
    s_lshr_b32 s48, s45, 3
    s_add_u32 s26, s46, s48
    s_lshl_b32 s48, s48, 1
    s_add_u32 s27, s47, s48
    v_lshrrev_b32 v1, 3, v0
    v_and_b32 v7, 7, v0
    s_cmp_ge_u32 s24, 8
    s_cbranch_scc1 k1_qkv_kernel_loader
    s_lshl_b32 s44, s25, 16
    s_add_u32 s46, s27, 0
    s_and_b32 s46, s46, 7
    s_lshl_b32 s47, s46, 7
    s_add_u32 s28, s47, s44
    s_add_u32 s46, s27, 1
    s_and_b32 s46, s46, 7
    s_lshl_b32 s47, s46, 7
    s_add_u32 s29, s47, s44
    s_add_u32 s46, s27, 2
    s_and_b32 s46, s46, 7
    s_lshl_b32 s47, s46, 7
    s_add_u32 s30, s47, s44
    s_add_u32 s46, s27, 3
    s_and_b32 s46, s46, 7
    s_lshl_b32 s47, s46, 7
    s_add_u32 s31, s47, s44
    s_add_u32 s46, s27, 4
    s_and_b32 s46, s46, 7
    s_lshl_b32 s47, s46, 7
    s_add_u32 s32, s47, s44
    s_add_u32 s46, s27, 5
    s_and_b32 s46, s46, 7
    s_lshl_b32 s47, s46, 7
    s_add_u32 s33, s47, s44
    s_add_u32 s46, s27, 6
    s_and_b32 s46, s46, 7
    s_lshl_b32 s47, s46, 7
    s_add_u32 s34, s47, s44
    s_add_u32 s46, s27, 7
    s_and_b32 s46, s46, 7
    s_lshl_b32 s47, s46, 7
    s_add_u32 s35, s47, s44
    s_lshl_b32 s44, s24, 3
    v_add_u32 v104, s44, v1
    v_lshlrev_b32 v2, 10, v104
    v_lshl_add_u32 v2, v7, 4, v2
    s_waitcnt lgkmcnt(0)
    s_mov_b32 s12, s4
    s_mov_b32 s13, s5
    s_mov_b32 s14, 2097152
    s_mov_b32 s15, 0x00020000
    buffer_load_dwordx4 v[8:11], v2, s[12:15], s28 offen
    buffer_load_dwordx4 v[12:15], v2, s[12:15], s29 offen
    buffer_load_dwordx4 v[16:19], v2, s[12:15], s30 offen
    buffer_load_dwordx4 v[20:23], v2, s[12:15], s31 offen
    buffer_load_dwordx4 v[24:27], v2, s[12:15], s32 offen
    buffer_load_dwordx4 v[28:31], v2, s[12:15], s33 offen
    buffer_load_dwordx4 v[32:35], v2, s[12:15], s34 offen
    buffer_load_dwordx4 v[36:39], v2, s[12:15], s35 offen
    s_barrier
    s_mov_b32 s20, s8
    s_mov_b32 s21, s9
    s_mov_b32 s22, 19070976
    s_mov_b32 s23, 0x00020000
    v_and_b32 v106, 15, v104
    v_xor_b32 v106, v106, v7
    v_lshlrev_b32 v106, 4, v106
    v_lshl_add_u32 v5, v104, 10, v106
    v_xor_b32 v6, 128, v5
    s_mov_b32 s50, 0xffff0000
    s_and_b32 s44, s24, 1
    s_bfe_u32 s45, s24, 0x10001
    v_and_b32 v120, 31, v0
    v_lshrrev_b32 v121, 5, v0
    s_lshl_b32 s46, s44, 5
    v_add_u32 v122, s46, v120
    v_xor_b32 v123, v121, v120
    v_and_b32 v123, 15, v123
    v_lshlrev_b32 v123, 4, v123
    v_lshl_add_u32 v108, v122, 10, v123
    v_xor_b32 v109, 32, v108
    v_xor_b32 v110, 64, v108
    v_xor_b32 v111, 96, v108
    v_xor_b32 v112, 128, v108
    v_xor_b32 v113, 160, v108
    v_xor_b32 v114, 192, v108
    v_xor_b32 v115, 224, v108
    v_bfe_u32 v123, v0, 2, 2
    v_lshl_add_u32 v122, v121, 3, v123
    v_lshlrev_b32 v116, 7, v122
    v_lshrrev_b32 v123, 1, v123
    v_xor_b32 v123, s45, v123
    v_lshl_add_u32 v116, v123, 6, v116
    v_bfe_u32 v123, v0, 4, 1
    v_lshl_add_u32 v116, v123, 5, v116
    v_and_b32 v123, 3, v0
    v_lshl_add_u32 v116, v123, 3, v116
    v_add_u32 v116, 65536, v116
    v_add_u32 v117, 49152, v116
    s_lshl_b32 s46, s26, 2
    s_lshl_b32 s47, s45, 1
    s_add_u32 s46, s46, s47
    s_lshl_b32 s47, s25, 1
    s_add_u32 s47, s47, s44
    s_lshl_b32 s46, s46, 6
    s_add_u32 s46, s46, s47
    s_lshl_b32 s46, s46, 10
    s_add_u32 s52, s46, 0
    s_add_u32 s53, s46, 65536
    s_add_u32 s54, s46, 2097152
    s_add_u32 s55, s46, 2162688
    s_add_u32 s56, s46, 4194304
    s_mov_b32 s57, 0x3eb8aa3b
    v_lshlrev_b32 v118, 4, v0
    v_bfe_u32 v119, v0, 4, 1
    v_lshlrev_b32 v119, 16, v119
    v_and_b32 v122, 15, v0
    v_lshl_add_u32 v119, v122, 4, v119
    v_lshl_add_u32 v119, v121, 8, v119
    v_mov_b32 v104, 0
    v_mov_b32 v105, 0
    v_mov_b32 v106, 0
    v_mov_b32 v107, 0
    s_waitcnt vmcnt(7)
    v_lshlrev_b32 v40, 16, v8
    v_and_b32 v41, s50, v8
    v_add_f32 v104, v104, v40
    v_fmac_f32 v106, v40, v40
    v_add_f32 v105, v105, v41
    v_fmac_f32 v107, v41, v41
    v_lshlrev_b32 v42, 16, v9
    v_and_b32 v43, s50, v9
    v_add_f32 v104, v104, v42
    v_fmac_f32 v106, v42, v42
    v_add_f32 v105, v105, v43
    v_fmac_f32 v107, v43, v43
    v_lshlrev_b32 v44, 16, v10
    v_and_b32 v45, s50, v10
    v_add_f32 v104, v104, v44
    v_fmac_f32 v106, v44, v44
    v_add_f32 v105, v105, v45
    v_fmac_f32 v107, v45, v45
    v_lshlrev_b32 v46, 16, v11
    v_and_b32 v47, s50, v11
    v_add_f32 v104, v104, v46
    v_fmac_f32 v106, v46, v46
    v_add_f32 v105, v105, v47
    v_fmac_f32 v107, v47, v47
    s_waitcnt vmcnt(6)
    v_lshlrev_b32 v48, 16, v12
    v_and_b32 v49, s50, v12
    v_add_f32 v104, v104, v48
    v_fmac_f32 v106, v48, v48
    v_add_f32 v105, v105, v49
    v_fmac_f32 v107, v49, v49
    v_lshlrev_b32 v50, 16, v13
    v_and_b32 v51, s50, v13
    v_add_f32 v104, v104, v50
    v_fmac_f32 v106, v50, v50
    v_add_f32 v105, v105, v51
    v_fmac_f32 v107, v51, v51
    v_lshlrev_b32 v52, 16, v14
    v_and_b32 v53, s50, v14
    v_add_f32 v104, v104, v52
    v_fmac_f32 v106, v52, v52
    v_add_f32 v105, v105, v53
    v_fmac_f32 v107, v53, v53
    v_lshlrev_b32 v54, 16, v15
    v_and_b32 v55, s50, v15
    v_add_f32 v104, v104, v54
    v_fmac_f32 v106, v54, v54
    v_add_f32 v105, v105, v55
    v_fmac_f32 v107, v55, v55
    s_waitcnt vmcnt(5)
    v_lshlrev_b32 v56, 16, v16
    v_and_b32 v57, s50, v16
    v_add_f32 v104, v104, v56
    v_fmac_f32 v106, v56, v56
    v_add_f32 v105, v105, v57
    v_fmac_f32 v107, v57, v57
    v_lshlrev_b32 v58, 16, v17
    v_and_b32 v59, s50, v17
    v_add_f32 v104, v104, v58
    v_fmac_f32 v106, v58, v58
    v_add_f32 v105, v105, v59
    v_fmac_f32 v107, v59, v59
    v_lshlrev_b32 v60, 16, v18
    v_and_b32 v61, s50, v18
    v_add_f32 v104, v104, v60
    v_fmac_f32 v106, v60, v60
    v_add_f32 v105, v105, v61
    v_fmac_f32 v107, v61, v61
    v_lshlrev_b32 v62, 16, v19
    v_and_b32 v63, s50, v19
    v_add_f32 v104, v104, v62
    v_fmac_f32 v106, v62, v62
    v_add_f32 v105, v105, v63
    v_fmac_f32 v107, v63, v63
    s_waitcnt vmcnt(4)
    v_lshlrev_b32 v64, 16, v20
    v_and_b32 v65, s50, v20
    v_add_f32 v104, v104, v64
    v_fmac_f32 v106, v64, v64
    v_add_f32 v105, v105, v65
    v_fmac_f32 v107, v65, v65
    v_lshlrev_b32 v66, 16, v21
    v_and_b32 v67, s50, v21
    v_add_f32 v104, v104, v66
    v_fmac_f32 v106, v66, v66
    v_add_f32 v105, v105, v67
    v_fmac_f32 v107, v67, v67
    v_lshlrev_b32 v68, 16, v22
    v_and_b32 v69, s50, v22
    v_add_f32 v104, v104, v68
    v_fmac_f32 v106, v68, v68
    v_add_f32 v105, v105, v69
    v_fmac_f32 v107, v69, v69
    v_lshlrev_b32 v70, 16, v23
    v_and_b32 v71, s50, v23
    v_add_f32 v104, v104, v70
    v_fmac_f32 v106, v70, v70
    v_add_f32 v105, v105, v71
    v_fmac_f32 v107, v71, v71
    s_waitcnt vmcnt(3)
    v_lshlrev_b32 v72, 16, v24
    v_and_b32 v73, s50, v24
    v_add_f32 v104, v104, v72
    v_fmac_f32 v106, v72, v72
    v_add_f32 v105, v105, v73
    v_fmac_f32 v107, v73, v73
    v_lshlrev_b32 v74, 16, v25
    v_and_b32 v75, s50, v25
    v_add_f32 v104, v104, v74
    v_fmac_f32 v106, v74, v74
    v_add_f32 v105, v105, v75
    v_fmac_f32 v107, v75, v75
    v_lshlrev_b32 v76, 16, v26
    v_and_b32 v77, s50, v26
    v_add_f32 v104, v104, v76
    v_fmac_f32 v106, v76, v76
    v_add_f32 v105, v105, v77
    v_fmac_f32 v107, v77, v77
    v_lshlrev_b32 v78, 16, v27
    v_and_b32 v79, s50, v27
    v_add_f32 v104, v104, v78
    v_fmac_f32 v106, v78, v78
    v_add_f32 v105, v105, v79
    v_fmac_f32 v107, v79, v79
    s_waitcnt vmcnt(2)
    v_lshlrev_b32 v80, 16, v28
    v_and_b32 v81, s50, v28
    v_add_f32 v104, v104, v80
    v_fmac_f32 v106, v80, v80
    v_add_f32 v105, v105, v81
    v_fmac_f32 v107, v81, v81
    v_lshlrev_b32 v82, 16, v29
    v_and_b32 v83, s50, v29
    v_add_f32 v104, v104, v82
    v_fmac_f32 v106, v82, v82
    v_add_f32 v105, v105, v83
    v_fmac_f32 v107, v83, v83
    v_lshlrev_b32 v84, 16, v30
    v_and_b32 v85, s50, v30
    v_add_f32 v104, v104, v84
    v_fmac_f32 v106, v84, v84
    v_add_f32 v105, v105, v85
    v_fmac_f32 v107, v85, v85
    v_lshlrev_b32 v86, 16, v31
    v_and_b32 v87, s50, v31
    v_add_f32 v104, v104, v86
    v_fmac_f32 v106, v86, v86
    v_add_f32 v105, v105, v87
    v_fmac_f32 v107, v87, v87
    s_waitcnt vmcnt(1)
    v_lshlrev_b32 v88, 16, v32
    v_and_b32 v89, s50, v32
    v_add_f32 v104, v104, v88
    v_fmac_f32 v106, v88, v88
    v_add_f32 v105, v105, v89
    v_fmac_f32 v107, v89, v89
    v_lshlrev_b32 v90, 16, v33
    v_and_b32 v91, s50, v33
    v_add_f32 v104, v104, v90
    v_fmac_f32 v106, v90, v90
    v_add_f32 v105, v105, v91
    v_fmac_f32 v107, v91, v91
    v_lshlrev_b32 v92, 16, v34
    v_and_b32 v93, s50, v34
    v_add_f32 v104, v104, v92
    v_fmac_f32 v106, v92, v92
    v_add_f32 v105, v105, v93
    v_fmac_f32 v107, v93, v93
    v_lshlrev_b32 v94, 16, v35
    v_and_b32 v95, s50, v35
    v_add_f32 v104, v104, v94
    v_fmac_f32 v106, v94, v94
    v_add_f32 v105, v105, v95
    v_fmac_f32 v107, v95, v95
    s_waitcnt vmcnt(0)
    v_lshlrev_b32 v96, 16, v36
    v_and_b32 v97, s50, v36
    v_add_f32 v104, v104, v96
    v_fmac_f32 v106, v96, v96
    v_add_f32 v105, v105, v97
    v_fmac_f32 v107, v97, v97
    v_lshlrev_b32 v98, 16, v37
    v_and_b32 v99, s50, v37
    v_add_f32 v104, v104, v98
    v_fmac_f32 v106, v98, v98
    v_add_f32 v105, v105, v99
    v_fmac_f32 v107, v99, v99
    v_lshlrev_b32 v100, 16, v38
    v_and_b32 v101, s50, v38
    v_add_f32 v104, v104, v100
    v_fmac_f32 v106, v100, v100
    v_add_f32 v105, v105, v101
    v_fmac_f32 v107, v101, v101
    v_lshlrev_b32 v102, 16, v39
    v_and_b32 v103, s50, v39
    v_add_f32 v104, v104, v102
    v_fmac_f32 v106, v102, v102
    v_add_f32 v105, v105, v103
    v_fmac_f32 v107, v103, v103
    v_add_f32 v104, v104, v105
    v_add_f32 v106, v106, v107
    s_nop 1
    v_add_f32_dpp v104, v104, v104 quad_perm:[1,0,3,2] row_mask:0xf bank_mask:0xf
    v_add_f32_dpp v106, v106, v106 quad_perm:[1,0,3,2] row_mask:0xf bank_mask:0xf
    s_nop 1
    v_add_f32_dpp v104, v104, v104 quad_perm:[2,3,0,1] row_mask:0xf bank_mask:0xf
    v_add_f32_dpp v106, v106, v106 quad_perm:[2,3,0,1] row_mask:0xf bank_mask:0xf
    s_nop 1
    v_add_f32_dpp v104, v104, v104 row_half_mirror row_mask:0xf bank_mask:0xf
    v_add_f32_dpp v106, v106, v106 row_half_mirror row_mask:0xf bank_mask:0xf
    v_mul_f32 v104, 0x3b000000, v104
    v_mul_f32 v106, 0x3b000000, v106
    v_fma_f32 v106, -v104, v104, v106
    v_max_f32 v106, 0, v106
    v_add_f32 v106, 0x3727c5ac, v106
    v_rsq_f32 v106, v106
    s_nop 0
    v_mul_f32 v105, v104, v106
    v_sub_f32 v105, 0, v105
    v_fma_f32 v40, v40, v106, v105
    v_fma_f32 v41, v41, v106, v105
    v_fma_f32 v42, v42, v106, v105
    v_fma_f32 v43, v43, v106, v105
    v_fma_f32 v44, v44, v106, v105
    v_fma_f32 v45, v45, v106, v105
    v_fma_f32 v46, v46, v106, v105
    v_fma_f32 v47, v47, v106, v105
    v_cvt_pk_bf16_f32 v8, v40, v41
    v_cvt_pk_bf16_f32 v9, v42, v43
    v_cvt_pk_bf16_f32 v10, v44, v45
    v_cvt_pk_bf16_f32 v11, v46, v47
    ds_write_b128 v5, v[8:11] offset:0
    v_fma_f32 v48, v48, v106, v105
    v_fma_f32 v49, v49, v106, v105
    v_fma_f32 v50, v50, v106, v105
    v_fma_f32 v51, v51, v106, v105
    v_fma_f32 v52, v52, v106, v105
    v_fma_f32 v53, v53, v106, v105
    v_fma_f32 v54, v54, v106, v105
    v_fma_f32 v55, v55, v106, v105
    v_cvt_pk_bf16_f32 v12, v48, v49
    v_cvt_pk_bf16_f32 v13, v50, v51
    v_cvt_pk_bf16_f32 v14, v52, v53
    v_cvt_pk_bf16_f32 v15, v54, v55
    ds_write_b128 v6, v[12:15] offset:0
    v_fma_f32 v56, v56, v106, v105
    v_fma_f32 v57, v57, v106, v105
    v_fma_f32 v58, v58, v106, v105
    v_fma_f32 v59, v59, v106, v105
    v_fma_f32 v60, v60, v106, v105
    v_fma_f32 v61, v61, v106, v105
    v_fma_f32 v62, v62, v106, v105
    v_fma_f32 v63, v63, v106, v105
    v_cvt_pk_bf16_f32 v16, v56, v57
    v_cvt_pk_bf16_f32 v17, v58, v59
    v_cvt_pk_bf16_f32 v18, v60, v61
    v_cvt_pk_bf16_f32 v19, v62, v63
    ds_write_b128 v5, v[16:19] offset:256
    v_fma_f32 v64, v64, v106, v105
    v_fma_f32 v65, v65, v106, v105
    v_fma_f32 v66, v66, v106, v105
    v_fma_f32 v67, v67, v106, v105
    v_fma_f32 v68, v68, v106, v105
    v_fma_f32 v69, v69, v106, v105
    v_fma_f32 v70, v70, v106, v105
    v_fma_f32 v71, v71, v106, v105
    v_cvt_pk_bf16_f32 v20, v64, v65
    v_cvt_pk_bf16_f32 v21, v66, v67
    v_cvt_pk_bf16_f32 v22, v68, v69
    v_cvt_pk_bf16_f32 v23, v70, v71
    ds_write_b128 v6, v[20:23] offset:256
    v_fma_f32 v72, v72, v106, v105
    v_fma_f32 v73, v73, v106, v105
    v_fma_f32 v74, v74, v106, v105
    v_fma_f32 v75, v75, v106, v105
    v_fma_f32 v76, v76, v106, v105
    v_fma_f32 v77, v77, v106, v105
    v_fma_f32 v78, v78, v106, v105
    v_fma_f32 v79, v79, v106, v105
    v_cvt_pk_bf16_f32 v24, v72, v73
    v_cvt_pk_bf16_f32 v25, v74, v75
    v_cvt_pk_bf16_f32 v26, v76, v77
    v_cvt_pk_bf16_f32 v27, v78, v79
    ds_write_b128 v5, v[24:27] offset:512
    v_fma_f32 v80, v80, v106, v105
    v_fma_f32 v81, v81, v106, v105
    v_fma_f32 v82, v82, v106, v105
    v_fma_f32 v83, v83, v106, v105
    v_fma_f32 v84, v84, v106, v105
    v_fma_f32 v85, v85, v106, v105
    v_fma_f32 v86, v86, v106, v105
    v_fma_f32 v87, v87, v106, v105
    v_cvt_pk_bf16_f32 v28, v80, v81
    v_cvt_pk_bf16_f32 v29, v82, v83
    v_cvt_pk_bf16_f32 v30, v84, v85
    v_cvt_pk_bf16_f32 v31, v86, v87
    ds_write_b128 v6, v[28:31] offset:512
    v_fma_f32 v88, v88, v106, v105
    v_fma_f32 v89, v89, v106, v105
    v_fma_f32 v90, v90, v106, v105
    v_fma_f32 v91, v91, v106, v105
    v_fma_f32 v92, v92, v106, v105
    v_fma_f32 v93, v93, v106, v105
    v_fma_f32 v94, v94, v106, v105
    v_fma_f32 v95, v95, v106, v105
    v_cvt_pk_bf16_f32 v32, v88, v89
    v_cvt_pk_bf16_f32 v33, v90, v91
    v_cvt_pk_bf16_f32 v34, v92, v93
    v_cvt_pk_bf16_f32 v35, v94, v95
    ds_write_b128 v5, v[32:35] offset:768
    v_fma_f32 v96, v96, v106, v105
    v_fma_f32 v97, v97, v106, v105
    v_fma_f32 v98, v98, v106, v105
    v_fma_f32 v99, v99, v106, v105
    v_fma_f32 v100, v100, v106, v105
    v_fma_f32 v101, v101, v106, v105
    v_fma_f32 v102, v102, v106, v105
    v_fma_f32 v103, v103, v106, v105
    v_cvt_pk_bf16_f32 v36, v96, v97
    v_cvt_pk_bf16_f32 v37, v98, v99
    v_cvt_pk_bf16_f32 v38, v100, v101
    v_cvt_pk_bf16_f32 v39, v102, v103
    ds_write_b128 v6, v[36:39] offset:768
    s_waitcnt lgkmcnt(0)
    s_barrier
    s_cmp_lt_u32 s24, 4
    s_cbranch_scc0 k1_qkv_kernel_end
    ds_read_b128 v[56:59], v108 offset:0
    ds_read_b64_tr_b16 v[60:61], v116 offset:0
    ds_read_b64_tr_b16 v[62:63], v116 offset:512
    ds_read_b64_tr_b16 v[64:65], v116 offset:8192
    ds_read_b64_tr_b16 v[66:67], v116 offset:8704
    ds_read_b128 v[68:71], v109 offset:0
    ds_read_b64_tr_b16 v[72:73], v116 offset:2048
    ds_read_b64_tr_b16 v[74:75], v116 offset:2560
    ds_read_b64_tr_b16 v[76:77], v116 offset:10240
    ds_read_b64_tr_b16 v[78:79], v116 offset:10752
    s_waitcnt lgkmcnt(5)
    v_mfma_f32_32x32x16_bf16 v[8:23], v[60:63], v[56:59], 0
    ds_read_b128 v[80:83], v110 offset:0
    ds_read_b64_tr_b16 v[84:85], v116 offset:4096
    ds_read_b64_tr_b16 v[86:87], v116 offset:4608
    v_mfma_f32_32x32x16_bf16 v[24:39], v[64:67], v[56:59], 0
    ds_read_b64_tr_b16 v[88:89], v116 offset:12288
    ds_read_b64_tr_b16 v[90:91], v116 offset:12800
    s_waitcnt lgkmcnt(5)
    v_mfma_f32_32x32x16_bf16 v[8:23], v[72:75], v[68:71], v[8:23]
    ds_read_b128 v[56:59], v111 offset:0
    ds_read_b64_tr_b16 v[60:61], v116 offset:6144
    ds_read_b64_tr_b16 v[62:63], v116 offset:6656
    v_mfma_f32_32x32x16_bf16 v[24:39], v[76:79], v[68:71], v[24:39]
    ds_read_b64_tr_b16 v[64:65], v116 offset:14336
    ds_read_b64_tr_b16 v[66:67], v116 offset:14848
    s_barrier
    s_waitcnt lgkmcnt(5)
    v_mfma_f32_32x32x16_bf16 v[8:23], v[84:87], v[80:83], v[8:23]
    ds_read_b128 v[68:71], v112 offset:0
    ds_read_b64_tr_b16 v[72:73], v116 offset:16384
    ds_read_b64_tr_b16 v[74:75], v116 offset:16896
    v_mfma_f32_32x32x16_bf16 v[24:39], v[88:91], v[80:83], v[24:39]
    ds_read_b64_tr_b16 v[76:77], v116 offset:24576
    ds_read_b64_tr_b16 v[78:79], v116 offset:25088
    s_waitcnt lgkmcnt(5)
    v_mfma_f32_32x32x16_bf16 v[8:23], v[60:63], v[56:59], v[8:23]
    ds_read_b128 v[80:83], v113 offset:0
    ds_read_b64_tr_b16 v[84:85], v116 offset:18432
    ds_read_b64_tr_b16 v[86:87], v116 offset:18944
    v_mfma_f32_32x32x16_bf16 v[24:39], v[64:67], v[56:59], v[24:39]
    ds_read_b64_tr_b16 v[88:89], v116 offset:26624
    ds_read_b64_tr_b16 v[90:91], v116 offset:27136
    s_waitcnt lgkmcnt(5)
    v_mfma_f32_32x32x16_bf16 v[8:23], v[72:75], v[68:71], v[8:23]
    ds_read_b128 v[56:59], v114 offset:0
    ds_read_b64_tr_b16 v[60:61], v116 offset:20480
    ds_read_b64_tr_b16 v[62:63], v116 offset:20992
    v_mfma_f32_32x32x16_bf16 v[24:39], v[76:79], v[68:71], v[24:39]
    ds_read_b64_tr_b16 v[64:65], v116 offset:28672
    ds_read_b64_tr_b16 v[66:67], v116 offset:29184
    s_waitcnt lgkmcnt(5)
    v_mfma_f32_32x32x16_bf16 v[8:23], v[84:87], v[80:83], v[8:23]
    ds_read_b128 v[68:71], v115 offset:0
    ds_read_b64_tr_b16 v[72:73], v116 offset:22528
    ds_read_b64_tr_b16 v[74:75], v116 offset:23040
    v_mfma_f32_32x32x16_bf16 v[24:39], v[88:91], v[80:83], v[24:39]
    ds_read_b64_tr_b16 v[76:77], v116 offset:30720
    ds_read_b64_tr_b16 v[78:79], v116 offset:31232
    s_barrier
    s_waitcnt lgkmcnt(5)
    v_mfma_f32_32x32x16_bf16 v[8:23], v[60:63], v[56:59], v[8:23]
    ds_read_b128 v[80:83], v108 offset:256
    ds_read_b64_tr_b16 v[84:85], v116 offset:32768
    ds_read_b64_tr_b16 v[86:87], v116 offset:33280
    v_mfma_f32_32x32x16_bf16 v[24:39], v[64:67], v[56:59], v[24:39]
    ds_read_b64_tr_b16 v[88:89], v116 offset:40960
    ds_read_b64_tr_b16 v[90:91], v116 offset:41472
    s_waitcnt lgkmcnt(5)
    v_mfma_f32_32x32x16_bf16 v[8:23], v[72:75], v[68:71], v[8:23]
    ds_read_b128 v[56:59], v109 offset:256
    ds_read_b64_tr_b16 v[60:61], v116 offset:34816
    ds_read_b64_tr_b16 v[62:63], v116 offset:35328
    v_mfma_f32_32x32x16_bf16 v[24:39], v[76:79], v[68:71], v[24:39]
    ds_read_b64_tr_b16 v[64:65], v116 offset:43008
    ds_read_b64_tr_b16 v[66:67], v116 offset:43520
    s_waitcnt lgkmcnt(5)
    v_mfma_f32_32x32x16_bf16 v[8:23], v[84:87], v[80:83], v[8:23]
    ds_read_b128 v[68:71], v110 offset:256
    ds_read_b64_tr_b16 v[72:73], v116 offset:36864
    ds_read_b64_tr_b16 v[74:75], v116 offset:37376
    v_mfma_f32_32x32x16_bf16 v[24:39], v[88:91], v[80:83], v[24:39]
    ds_read_b64_tr_b16 v[76:77], v116 offset:45056
    ds_read_b64_tr_b16 v[78:79], v116 offset:45568
    s_waitcnt lgkmcnt(5)
    v_mfma_f32_32x32x16_bf16 v[8:23], v[60:63], v[56:59], v[8:23]
    ds_read_b128 v[80:83], v111 offset:256
    ds_read_b64_tr_b16 v[84:85], v116 offset:38912
    ds_read_b64_tr_b16 v[86:87], v116 offset:39424
    v_mfma_f32_32x32x16_bf16 v[24:39], v[64:67], v[56:59], v[24:39]
    ds_read_b64_tr_b16 v[88:89], v116 offset:47104
    ds_read_b64_tr_b16 v[90:91], v116 offset:47616
    s_barrier
    s_waitcnt lgkmcnt(5)
    v_mfma_f32_32x32x16_bf16 v[8:23], v[72:75], v[68:71], v[8:23]
    ds_read_b128 v[56:59], v112 offset:256
    ds_read_b64_tr_b16 v[60:61], v117 offset:0
    ds_read_b64_tr_b16 v[62:63], v117 offset:512
    v_mfma_f32_32x32x16_bf16 v[24:39], v[76:79], v[68:71], v[24:39]
    ds_read_b64_tr_b16 v[64:65], v117 offset:8192
    ds_read_b64_tr_b16 v[66:67], v117 offset:8704
    s_waitcnt lgkmcnt(5)
    v_mfma_f32_32x32x16_bf16 v[8:23], v[84:87], v[80:83], v[8:23]
    ds_read_b128 v[68:71], v113 offset:256
    ds_read_b64_tr_b16 v[72:73], v117 offset:2048
    ds_read_b64_tr_b16 v[74:75], v117 offset:2560
    v_mfma_f32_32x32x16_bf16 v[24:39], v[88:91], v[80:83], v[24:39]
    ds_read_b64_tr_b16 v[76:77], v117 offset:10240
    ds_read_b64_tr_b16 v[78:79], v117 offset:10752
    s_waitcnt lgkmcnt(5)
    v_mfma_f32_32x32x16_bf16 v[8:23], v[60:63], v[56:59], v[8:23]
    ds_read_b128 v[80:83], v114 offset:256
    ds_read_b64_tr_b16 v[84:85], v117 offset:4096
    ds_read_b64_tr_b16 v[86:87], v117 offset:4608
    v_mfma_f32_32x32x16_bf16 v[24:39], v[64:67], v[56:59], v[24:39]
    ds_read_b64_tr_b16 v[88:89], v117 offset:12288
    ds_read_b64_tr_b16 v[90:91], v117 offset:12800
    s_waitcnt lgkmcnt(5)
    v_mfma_f32_32x32x16_bf16 v[8:23], v[72:75], v[68:71], v[8:23]
    ds_read_b128 v[56:59], v115 offset:256
    ds_read_b64_tr_b16 v[60:61], v117 offset:6144
    ds_read_b64_tr_b16 v[62:63], v117 offset:6656
    v_mfma_f32_32x32x16_bf16 v[24:39], v[76:79], v[68:71], v[24:39]
    ds_read_b64_tr_b16 v[64:65], v117 offset:14336
    ds_read_b64_tr_b16 v[66:67], v117 offset:14848
    s_barrier
    s_waitcnt lgkmcnt(5)
    v_mfma_f32_32x32x16_bf16 v[8:23], v[84:87], v[80:83], v[8:23]
    ds_read_b128 v[68:71], v108 offset:512
    ds_read_b64_tr_b16 v[72:73], v117 offset:16384
    ds_read_b64_tr_b16 v[74:75], v117 offset:16896
    v_mfma_f32_32x32x16_bf16 v[24:39], v[88:91], v[80:83], v[24:39]
    ds_read_b64_tr_b16 v[76:77], v117 offset:24576
    ds_read_b64_tr_b16 v[78:79], v117 offset:25088
    s_waitcnt lgkmcnt(5)
    v_mfma_f32_32x32x16_bf16 v[8:23], v[60:63], v[56:59], v[8:23]
    ds_read_b128 v[80:83], v109 offset:512
    ds_read_b64_tr_b16 v[84:85], v117 offset:18432
    ds_read_b64_tr_b16 v[86:87], v117 offset:18944
    v_mfma_f32_32x32x16_bf16 v[24:39], v[64:67], v[56:59], v[24:39]
    ds_read_b64_tr_b16 v[88:89], v117 offset:26624
    ds_read_b64_tr_b16 v[90:91], v117 offset:27136
    s_waitcnt lgkmcnt(5)
    v_mfma_f32_32x32x16_bf16 v[8:23], v[72:75], v[68:71], v[8:23]
    ds_read_b128 v[56:59], v110 offset:512
    ds_read_b64_tr_b16 v[60:61], v117 offset:20480
    ds_read_b64_tr_b16 v[62:63], v117 offset:20992
    v_mfma_f32_32x32x16_bf16 v[24:39], v[76:79], v[68:71], v[24:39]
    ds_read_b64_tr_b16 v[64:65], v117 offset:28672
    ds_read_b64_tr_b16 v[66:67], v117 offset:29184
    s_waitcnt lgkmcnt(5)
    v_mfma_f32_32x32x16_bf16 v[8:23], v[84:87], v[80:83], v[8:23]
    ds_read_b128 v[68:71], v111 offset:512
    ds_read_b64_tr_b16 v[72:73], v117 offset:22528
    ds_read_b64_tr_b16 v[74:75], v117 offset:23040
    v_mfma_f32_32x32x16_bf16 v[24:39], v[88:91], v[80:83], v[24:39]
    ds_read_b64_tr_b16 v[76:77], v117 offset:30720
    ds_read_b64_tr_b16 v[78:79], v117 offset:31232
    s_barrier
    s_waitcnt lgkmcnt(5)
    v_mfma_f32_32x32x16_bf16 v[8:23], v[60:63], v[56:59], v[8:23]
    ds_read_b128 v[80:83], v112 offset:512
    ds_read_b64_tr_b16 v[84:85], v117 offset:32768
    ds_read_b64_tr_b16 v[86:87], v117 offset:33280
    v_mfma_f32_32x32x16_bf16 v[24:39], v[64:67], v[56:59], v[24:39]
    ds_read_b64_tr_b16 v[88:89], v117 offset:40960
    ds_read_b64_tr_b16 v[90:91], v117 offset:41472
    s_waitcnt lgkmcnt(5)
    v_mfma_f32_32x32x16_bf16 v[8:23], v[72:75], v[68:71], v[8:23]
    ds_read_b128 v[56:59], v113 offset:512
    ds_read_b64_tr_b16 v[60:61], v117 offset:34816
    ds_read_b64_tr_b16 v[62:63], v117 offset:35328
    v_mfma_f32_32x32x16_bf16 v[24:39], v[76:79], v[68:71], v[24:39]
    ds_read_b64_tr_b16 v[64:65], v117 offset:43008
    ds_read_b64_tr_b16 v[66:67], v117 offset:43520
    s_waitcnt lgkmcnt(5)
    v_mfma_f32_32x32x16_bf16 v[8:23], v[84:87], v[80:83], v[8:23]
    ds_read_b128 v[68:71], v114 offset:512
    ds_read_b64_tr_b16 v[72:73], v117 offset:36864
    ds_read_b64_tr_b16 v[74:75], v117 offset:37376
    v_mfma_f32_32x32x16_bf16 v[24:39], v[88:91], v[80:83], v[24:39]
    ds_read_b64_tr_b16 v[76:77], v117 offset:45056
    ds_read_b64_tr_b16 v[78:79], v117 offset:45568
    s_waitcnt lgkmcnt(5)
    v_mfma_f32_32x32x16_bf16 v[8:23], v[60:63], v[56:59], v[8:23]
    ds_read_b128 v[80:83], v115 offset:512
    ds_read_b64_tr_b16 v[84:85], v117 offset:38912
    ds_read_b64_tr_b16 v[86:87], v117 offset:39424
    v_mfma_f32_32x32x16_bf16 v[24:39], v[64:67], v[56:59], v[24:39]
    ds_read_b64_tr_b16 v[88:89], v117 offset:47104
    ds_read_b64_tr_b16 v[90:91], v117 offset:47616
    s_barrier
    s_waitcnt lgkmcnt(5)
    v_mfma_f32_32x32x16_bf16 v[8:23], v[72:75], v[68:71], v[8:23]
    ds_read_b128 v[56:59], v108 offset:768
    ds_read_b64_tr_b16 v[60:61], v116 offset:0
    ds_read_b64_tr_b16 v[62:63], v116 offset:512
    v_mfma_f32_32x32x16_bf16 v[24:39], v[76:79], v[68:71], v[24:39]
    ds_read_b64_tr_b16 v[64:65], v116 offset:8192
    ds_read_b64_tr_b16 v[66:67], v116 offset:8704
    s_waitcnt lgkmcnt(5)
    v_mfma_f32_32x32x16_bf16 v[8:23], v[84:87], v[80:83], v[8:23]
    ds_read_b128 v[68:71], v109 offset:768
    ds_read_b64_tr_b16 v[72:73], v116 offset:2048
    ds_read_b64_tr_b16 v[74:75], v116 offset:2560
    v_mfma_f32_32x32x16_bf16 v[24:39], v[88:91], v[80:83], v[24:39]
    ds_read_b64_tr_b16 v[76:77], v116 offset:10240
    ds_read_b64_tr_b16 v[78:79], v116 offset:10752
    s_waitcnt lgkmcnt(5)
    v_mfma_f32_32x32x16_bf16 v[8:23], v[60:63], v[56:59], v[8:23]
    ds_read_b128 v[80:83], v110 offset:768
    ds_read_b64_tr_b16 v[84:85], v116 offset:4096
    ds_read_b64_tr_b16 v[86:87], v116 offset:4608
    v_mfma_f32_32x32x16_bf16 v[24:39], v[64:67], v[56:59], v[24:39]
    ds_read_b64_tr_b16 v[88:89], v116 offset:12288
    ds_read_b64_tr_b16 v[90:91], v116 offset:12800
    s_waitcnt lgkmcnt(5)
    v_mfma_f32_32x32x16_bf16 v[8:23], v[72:75], v[68:71], v[8:23]
    ds_read_b128 v[56:59], v111 offset:768
    ds_read_b64_tr_b16 v[60:61], v116 offset:6144
    ds_read_b64_tr_b16 v[62:63], v116 offset:6656
    v_mfma_f32_32x32x16_bf16 v[24:39], v[76:79], v[68:71], v[24:39]
    ds_read_b64_tr_b16 v[64:65], v116 offset:14336
    ds_read_b64_tr_b16 v[66:67], v116 offset:14848
    s_barrier
    s_waitcnt lgkmcnt(5)
    v_mfma_f32_32x32x16_bf16 v[8:23], v[84:87], v[80:83], v[8:23]
    ds_read_b128 v[68:71], v112 offset:768
    ds_read_b64_tr_b16 v[72:73], v116 offset:16384
    ds_read_b64_tr_b16 v[74:75], v116 offset:16896
    v_mfma_f32_32x32x16_bf16 v[24:39], v[88:91], v[80:83], v[24:39]
    ds_read_b64_tr_b16 v[76:77], v116 offset:24576
    ds_read_b64_tr_b16 v[78:79], v116 offset:25088
    s_waitcnt lgkmcnt(5)
    v_mfma_f32_32x32x16_bf16 v[8:23], v[60:63], v[56:59], v[8:23]
    ds_read_b128 v[80:83], v113 offset:768
    ds_read_b64_tr_b16 v[84:85], v116 offset:18432
    ds_read_b64_tr_b16 v[86:87], v116 offset:18944
    v_mfma_f32_32x32x16_bf16 v[24:39], v[64:67], v[56:59], v[24:39]
    ds_read_b64_tr_b16 v[88:89], v116 offset:26624
    ds_read_b64_tr_b16 v[90:91], v116 offset:27136
    s_waitcnt lgkmcnt(5)
    v_mfma_f32_32x32x16_bf16 v[8:23], v[72:75], v[68:71], v[8:23]
    ds_read_b128 v[56:59], v114 offset:768
    ds_read_b64_tr_b16 v[60:61], v116 offset:20480
    ds_read_b64_tr_b16 v[62:63], v116 offset:20992
    v_mfma_f32_32x32x16_bf16 v[24:39], v[76:79], v[68:71], v[24:39]
    ds_read_b64_tr_b16 v[64:65], v116 offset:28672
    ds_read_b64_tr_b16 v[66:67], v116 offset:29184
    s_waitcnt lgkmcnt(5)
    v_mfma_f32_32x32x16_bf16 v[8:23], v[84:87], v[80:83], v[8:23]
    ds_read_b128 v[68:71], v115 offset:768
    ds_read_b64_tr_b16 v[72:73], v116 offset:22528
    ds_read_b64_tr_b16 v[74:75], v116 offset:23040
    v_mfma_f32_32x32x16_bf16 v[24:39], v[88:91], v[80:83], v[24:39]
    ds_read_b64_tr_b16 v[76:77], v116 offset:30720
    ds_read_b64_tr_b16 v[78:79], v116 offset:31232
    s_barrier
    s_waitcnt lgkmcnt(5)
    v_mfma_f32_32x32x16_bf16 v[8:23], v[60:63], v[56:59], v[8:23]
    ds_read_b128 v[80:83], v108 offset:0
    ds_read_b64_tr_b16 v[84:85], v116 offset:32768
    v_mfma_f32_32x32x16_bf16 v[24:39], v[64:67], v[56:59], v[24:39]
    ds_read_b64_tr_b16 v[86:87], v116 offset:33280
    s_waitcnt lgkmcnt(3)
    v_mfma_f32_32x32x16_bf16 v[8:23], v[72:75], v[68:71], v[8:23]
    ds_read_b128 v[56:59], v109 offset:0
    ds_read_b64_tr_b16 v[60:61], v116 offset:34816
    v_mfma_f32_32x32x16_bf16 v[24:39], v[76:79], v[68:71], v[24:39]
    ds_read_b64_tr_b16 v[62:63], v116 offset:35328
    s_waitcnt lgkmcnt(3)
    v_mfma_f32_32x32x16_bf16 v[40:55], v[80:83], v[84:87], 0
    ds_read_b128 v[68:71], v110 offset:0
    ds_read_b64_tr_b16 v[72:73], v116 offset:36864
    ds_read_b64_tr_b16 v[74:75], v116 offset:37376
    s_waitcnt lgkmcnt(3)
    v_mfma_f32_32x32x16_bf16 v[40:55], v[56:59], v[60:63], v[40:55]
    ds_read_b128 v[80:83], v111 offset:0
    ds_read_b64_tr_b16 v[84:85], v116 offset:38912
    ds_read_b64_tr_b16 v[86:87], v116 offset:39424
    s_waitcnt lgkmcnt(3)
    v_mfma_f32_32x32x16_bf16 v[40:55], v[68:71], v[72:75], v[40:55]
    ds_read_b128 v[56:59], v112 offset:0
    ds_read_b64_tr_b16 v[60:61], v116 offset:40960
    ds_read_b64_tr_b16 v[62:63], v116 offset:41472
    s_waitcnt lgkmcnt(3)
    v_mfma_f32_32x32x16_bf16 v[40:55], v[80:83], v[84:87], v[40:55]
    ds_read_b128 v[68:71], v113 offset:0
    ds_read_b64_tr_b16 v[72:73], v116 offset:43008
    ds_read_b64_tr_b16 v[74:75], v116 offset:43520
    s_waitcnt lgkmcnt(3)
    v_mfma_f32_32x32x16_bf16 v[40:55], v[56:59], v[60:63], v[40:55]
    ds_read_b128 v[80:83], v114 offset:0
    ds_read_b64_tr_b16 v[84:85], v116 offset:45056
    ds_read_b64_tr_b16 v[86:87], v116 offset:45568
    v_mul_f32 v8, s57, v8
    v_mul_f32 v9, s57, v9
    s_waitcnt lgkmcnt(3)
    v_mfma_f32_32x32x16_bf16 v[40:55], v[68:71], v[72:75], v[40:55]
    ds_read_b128 v[56:59], v115 offset:0
    ds_read_b64_tr_b16 v[60:61], v116 offset:47104
    ds_read_b64_tr_b16 v[62:63], v116 offset:47616
    v_mul_f32 v10, s57, v10
    v_mul_f32 v11, s57, v11
    s_barrier
    s_waitcnt lgkmcnt(3)
    v_mfma_f32_32x32x16_bf16 v[40:55], v[80:83], v[84:87], v[40:55]
    ds_read_b128 v[68:71], v108 offset:256
    ds_read_b64_tr_b16 v[72:73], v117 offset:0
    ds_read_b64_tr_b16 v[74:75], v117 offset:512
    v_mul_f32 v12, s57, v12
    v_mul_f32 v13, s57, v13
    s_waitcnt lgkmcnt(3)
    v_mfma_f32_32x32x16_bf16 v[40:55], v[56:59], v[60:63], v[40:55]
    ds_read_b128 v[80:83], v109 offset:256
    ds_read_b64_tr_b16 v[84:85], v117 offset:2048
    ds_read_b64_tr_b16 v[86:87], v117 offset:2560
    v_mul_f32 v14, s57, v14
    v_mul_f32 v15, s57, v15
    s_waitcnt lgkmcnt(3)
    v_mfma_f32_32x32x16_bf16 v[40:55], v[68:71], v[72:75], v[40:55]
    ds_read_b128 v[56:59], v110 offset:256
    ds_read_b64_tr_b16 v[60:61], v117 offset:4096
    ds_read_b64_tr_b16 v[62:63], v117 offset:4608
    v_mul_f32 v16, s57, v16
    v_mul_f32 v17, s57, v17
    s_waitcnt lgkmcnt(3)
    v_mfma_f32_32x32x16_bf16 v[40:55], v[80:83], v[84:87], v[40:55]
    ds_read_b128 v[68:71], v111 offset:256
    ds_read_b64_tr_b16 v[72:73], v117 offset:6144
    ds_read_b64_tr_b16 v[74:75], v117 offset:6656
    v_mul_f32 v18, s57, v18
    v_mul_f32 v19, s57, v19
    s_waitcnt lgkmcnt(3)
    v_mfma_f32_32x32x16_bf16 v[40:55], v[56:59], v[60:63], v[40:55]
    ds_read_b128 v[80:83], v112 offset:256
    ds_read_b64_tr_b16 v[84:85], v117 offset:8192
    ds_read_b64_tr_b16 v[86:87], v117 offset:8704
    v_mul_f32 v20, s57, v20
    v_mul_f32 v21, s57, v21
    s_waitcnt lgkmcnt(3)
    v_mfma_f32_32x32x16_bf16 v[40:55], v[68:71], v[72:75], v[40:55]
    ds_read_b128 v[56:59], v113 offset:256
    ds_read_b64_tr_b16 v[60:61], v117 offset:10240
    ds_read_b64_tr_b16 v[62:63], v117 offset:10752
    v_mul_f32 v22, s57, v22
    v_mul_f32 v23, s57, v23
    s_waitcnt lgkmcnt(3)
    v_mfma_f32_32x32x16_bf16 v[40:55], v[80:83], v[84:87], v[40:55]
    ds_read_b128 v[68:71], v114 offset:256
    ds_read_b64_tr_b16 v[72:73], v117 offset:12288
    ds_read_b64_tr_b16 v[74:75], v117 offset:12800
    v_cvt_pk_bf16_f32 v92, v8, v9
    v_cvt_pk_bf16_f32 v93, v10, v11
    s_waitcnt lgkmcnt(3)
    v_mfma_f32_32x32x16_bf16 v[40:55], v[56:59], v[60:63], v[40:55]
    ds_read_b128 v[80:83], v115 offset:256
    ds_read_b64_tr_b16 v[84:85], v117 offset:14336
    ds_read_b64_tr_b16 v[86:87], v117 offset:14848
    v_cvt_pk_bf16_f32 v94, v12, v13
    v_cvt_pk_bf16_f32 v95, v14, v15
    s_barrier
    s_waitcnt lgkmcnt(3)
    v_mfma_f32_32x32x16_bf16 v[40:55], v[68:71], v[72:75], v[40:55]
    ds_read_b128 v[56:59], v108 offset:512
    ds_read_b64_tr_b16 v[60:61], v117 offset:16384
    ds_read_b64_tr_b16 v[62:63], v117 offset:16896
    v_cvt_pk_bf16_f32 v96, v16, v17
    v_cvt_pk_bf16_f32 v97, v18, v19
    s_waitcnt lgkmcnt(3)
    v_mfma_f32_32x32x16_bf16 v[40:55], v[80:83], v[84:87], v[40:55]
    ds_read_b128 v[68:71], v109 offset:512
    ds_read_b64_tr_b16 v[72:73], v117 offset:18432
    ds_read_b64_tr_b16 v[74:75], v117 offset:18944
    v_cvt_pk_bf16_f32 v98, v20, v21
    v_cvt_pk_bf16_f32 v99, v22, v23
    s_waitcnt lgkmcnt(3)
    v_mfma_f32_32x32x16_bf16 v[40:55], v[56:59], v[60:63], v[40:55]
    ds_read_b128 v[80:83], v110 offset:512
    ds_read_b64_tr_b16 v[84:85], v117 offset:20480
    ds_read_b64_tr_b16 v[86:87], v117 offset:20992
    buffer_store_dwordx4 v[92:95], v118, s[20:23], s52 offen sc1
    buffer_store_dwordx4 v[96:99], v118, s[20:23], s53 offen sc1
    s_waitcnt lgkmcnt(3)
    v_mfma_f32_32x32x16_bf16 v[40:55], v[68:71], v[72:75], v[40:55]
    ds_read_b128 v[56:59], v111 offset:512
    ds_read_b64_tr_b16 v[60:61], v117 offset:22528
    ds_read_b64_tr_b16 v[62:63], v117 offset:23040
    v_cvt_pk_bf16_f32 v100, v24, v25
    v_cvt_pk_bf16_f32 v101, v26, v27
    s_waitcnt lgkmcnt(3)
    v_mfma_f32_32x32x16_bf16 v[40:55], v[80:83], v[84:87], v[40:55]
    ds_read_b128 v[68:71], v112 offset:512
    ds_read_b64_tr_b16 v[72:73], v117 offset:24576
    ds_read_b64_tr_b16 v[74:75], v117 offset:25088
    v_cvt_pk_bf16_f32 v102, v28, v29
    v_cvt_pk_bf16_f32 v103, v30, v31
    s_waitcnt lgkmcnt(3)
    v_mfma_f32_32x32x16_bf16 v[40:55], v[56:59], v[60:63], v[40:55]
    ds_read_b128 v[80:83], v113 offset:512
    ds_read_b64_tr_b16 v[84:85], v117 offset:26624
    ds_read_b64_tr_b16 v[86:87], v117 offset:27136
    v_cvt_pk_bf16_f32 v104, v32, v33
    v_cvt_pk_bf16_f32 v105, v34, v35
    s_waitcnt lgkmcnt(3)
    v_mfma_f32_32x32x16_bf16 v[40:55], v[68:71], v[72:75], v[40:55]
    ds_read_b128 v[56:59], v114 offset:512
    ds_read_b64_tr_b16 v[60:61], v117 offset:28672
    ds_read_b64_tr_b16 v[62:63], v117 offset:29184
    v_cvt_pk_bf16_f32 v106, v36, v37
    v_cvt_pk_bf16_f32 v107, v38, v39
    s_waitcnt lgkmcnt(3)
    v_mfma_f32_32x32x16_bf16 v[40:55], v[80:83], v[84:87], v[40:55]
    ds_read_b128 v[68:71], v115 offset:512
    ds_read_b64_tr_b16 v[72:73], v117 offset:30720
    ds_read_b64_tr_b16 v[74:75], v117 offset:31232
    buffer_store_dwordx4 v[100:103], v118, s[20:23], s54 offen sc1
    buffer_store_dwordx4 v[104:107], v118, s[20:23], s55 offen sc1
    s_barrier
    s_waitcnt lgkmcnt(3)
    v_mfma_f32_32x32x16_bf16 v[40:55], v[56:59], v[60:63], v[40:55]
    ds_read_b128 v[80:83], v108 offset:768
    ds_read_b64_tr_b16 v[84:85], v117 offset:32768
    ds_read_b64_tr_b16 v[86:87], v117 offset:33280
    s_waitcnt lgkmcnt(3)
    v_mfma_f32_32x32x16_bf16 v[40:55], v[68:71], v[72:75], v[40:55]
    ds_read_b128 v[56:59], v109 offset:768
    ds_read_b64_tr_b16 v[60:61], v117 offset:34816
    ds_read_b64_tr_b16 v[62:63], v117 offset:35328
    s_waitcnt lgkmcnt(3)
    v_mfma_f32_32x32x16_bf16 v[40:55], v[80:83], v[84:87], v[40:55]
    ds_read_b128 v[68:71], v110 offset:768
    ds_read_b64_tr_b16 v[72:73], v117 offset:36864
    ds_read_b64_tr_b16 v[74:75], v117 offset:37376
    s_waitcnt lgkmcnt(3)
    v_mfma_f32_32x32x16_bf16 v[40:55], v[56:59], v[60:63], v[40:55]
    ds_read_b128 v[80:83], v111 offset:768
    ds_read_b64_tr_b16 v[84:85], v117 offset:38912
    ds_read_b64_tr_b16 v[86:87], v117 offset:39424
    s_waitcnt lgkmcnt(3)
    v_mfma_f32_32x32x16_bf16 v[40:55], v[68:71], v[72:75], v[40:55]
    ds_read_b128 v[56:59], v112 offset:768
    ds_read_b64_tr_b16 v[60:61], v117 offset:40960
    ds_read_b64_tr_b16 v[62:63], v117 offset:41472
    s_waitcnt lgkmcnt(3)
    v_mfma_f32_32x32x16_bf16 v[40:55], v[80:83], v[84:87], v[40:55]
    ds_read_b128 v[68:71], v113 offset:768
    ds_read_b64_tr_b16 v[72:73], v117 offset:43008
    ds_read_b64_tr_b16 v[74:75], v117 offset:43520
    s_waitcnt lgkmcnt(3)
    v_mfma_f32_32x32x16_bf16 v[40:55], v[56:59], v[60:63], v[40:55]
    ds_read_b128 v[80:83], v114 offset:768
    ds_read_b64_tr_b16 v[84:85], v117 offset:45056
    ds_read_b64_tr_b16 v[86:87], v117 offset:45568
    s_waitcnt lgkmcnt(3)
    v_mfma_f32_32x32x16_bf16 v[40:55], v[68:71], v[72:75], v[40:55]
    ds_read_b128 v[56:59], v115 offset:768
    ds_read_b64_tr_b16 v[60:61], v117 offset:47104
    ds_read_b64_tr_b16 v[62:63], v117 offset:47616
    s_waitcnt lgkmcnt(3)
    v_mfma_f32_32x32x16_bf16 v[40:55], v[80:83], v[84:87], v[40:55]
    s_waitcnt lgkmcnt(0)
    v_mfma_f32_32x32x16_bf16 v[40:55], v[56:59], v[60:63], v[40:55]
    s_nop 7
    s_nop 3
    v_cvt_pk_bf16_f32 v56, v40, v41
    v_cvt_pk_bf16_f32 v57, v42, v43
    v_cvt_pk_bf16_f32 v58, v44, v45
    v_cvt_pk_bf16_f32 v59, v46, v47
    v_cvt_pk_bf16_f32 v60, v48, v49
    v_cvt_pk_bf16_f32 v61, v50, v51
    v_cvt_pk_bf16_f32 v62, v52, v53
    v_cvt_pk_bf16_f32 v63, v54, v55
    buffer_store_dwordx4 v[56:59], v119, s[20:23], s56 offen sc1
    buffer_store_dwordx4 v[60:63], v119, s[20:23], s56 offen offset:512 sc1
    s_branch k1_qkv_kernel_end
k1_qkv_kernel_loader:
    s_setprio 2
    s_sub_u32 s49, s24, 8
    s_lshl_b32 s45, s26, 7
    s_add_u32 s46, s27, 0
    s_and_b32 s46, s46, 7
    s_mul_i32 s47, s46, 196608
    s_add_u32 s36, s47, s45
    s_add_u32 s46, s27, 1
    s_and_b32 s46, s46, 7
    s_mul_i32 s47, s46, 196608
    s_add_u32 s37, s47, s45
    s_add_u32 s46, s27, 2
    s_and_b32 s46, s46, 7
    s_mul_i32 s47, s46, 196608
    s_add_u32 s38, s47, s45
    s_add_u32 s46, s27, 3
    s_and_b32 s46, s46, 7
    s_mul_i32 s47, s46, 196608
    s_add_u32 s39, s47, s45
    s_add_u32 s46, s27, 4
    s_and_b32 s46, s46, 7
    s_mul_i32 s47, s46, 196608
    s_add_u32 s40, s47, s45
    s_add_u32 s46, s27, 5
    s_and_b32 s46, s46, 7
    s_mul_i32 s47, s46, 196608
    s_add_u32 s41, s47, s45
    s_add_u32 s46, s27, 6
    s_and_b32 s46, s46, 7
    s_mul_i32 s47, s46, 196608
    s_add_u32 s42, s47, s45
    s_add_u32 s46, s27, 7
    s_and_b32 s46, s46, 7
    s_mul_i32 s47, s46, 196608
    s_add_u32 s43, s47, s45
    v_lshlrev_b32 v105, 1, v1
    v_and_b32 v105, 4, v105
    v_xor_b32 v105, v105, v7
    v_lshlrev_b32 v105, 4, v105
    s_lshl_b32 s45, s49, 4
    v_add_u32 v106, s45, v1
    v_mul_u32_u24 v4, 3072, v106
    v_add_u32 v4, v4, v105
    s_lshl_b32 s51, s49, 11
    s_waitcnt lgkmcnt(0)
    s_mov_b32 s16, s6
    s_mov_b32 s17, s7
    s_mov_b32 s18, 1572864
    s_mov_b32 s19, 0x00020000
    s_mov_b32 s20, s8
    s_mov_b32 s21, s9
    s_mov_b32 s22, 19070976
    s_mov_b32 s23, 0x00020000
    s_cmp_lg_u32 s49, 0
    s_cbranch_scc1 k1_qkv_kernel_nz
    v_lshlrev_b32 v8, 15, v0
    v_mov_b32 v10, 0
    v_mov_b32 v11, 0
    s_lshl_b32 s46, s2, 7
    s_add_u32 s46, s46, 18874368
    s_mov_b64 exec, 31
    buffer_store_dwordx2 v[10:11], v8, s[20:23], s46 offen sc1
    s_mov_b64 exec, -1
k1_qkv_kernel_nz:
    s_barrier
    v_and_b32 v8, 15, v0
    v_add_u32 v8, s45, v8
    v_mul_u32_u24 v8, 3072, v8
    s_add_u32 s44, s36, 2048
    buffer_load_dword v9, v8, s[16:19], s44 offen
    s_add_u32 m0, s51, 65536
    s_add_u32 s44, s36, 0
    s_add_u32 s45, s36, 23552
    buffer_load_dwordx4 v4, s[16:19], s44 offen lds
    buffer_load_dwordx4 v4, s[16:19], s45 offen offset:1024 lds
    s_add_u32 m0, s51, 73728
    s_add_u32 s44, s36, 1024
    s_add_u32 s45, s36, 24576
    buffer_load_dwordx4 v4, s[16:19], s44 offen lds
    buffer_load_dwordx4 v4, s[16:19], s45 offen offset:1024 lds
    s_add_u32 m0, s51, 81920
    s_add_u32 s44, s37, 0
    s_add_u32 s45, s37, 23552
    buffer_load_dwordx4 v4, s[16:19], s44 offen lds
    buffer_load_dwordx4 v4, s[16:19], s45 offen offset:1024 lds
    s_add_u32 m0, s51, 90112
    s_add_u32 s44, s37, 1024
    s_add_u32 s45, s37, 24576
    buffer_load_dwordx4 v4, s[16:19], s44 offen lds
    buffer_load_dwordx4 v4, s[16:19], s45 offen offset:1024 lds
    s_add_u32 m0, s51, 98304
    s_add_u32 s44, s38, 0
    s_add_u32 s45, s38, 23552
    buffer_load_dwordx4 v4, s[16:19], s44 offen lds
    buffer_load_dwordx4 v4, s[16:19], s45 offen offset:1024 lds
    s_add_u32 m0, s51, 106496
    s_add_u32 s44, s38, 1024
    s_add_u32 s45, s38, 24576
    buffer_load_dwordx4 v4, s[16:19], s44 offen lds
    buffer_load_dwordx4 v4, s[16:19], s45 offen offset:1024 lds
    s_add_u32 m0, s51, 114688
    s_add_u32 s44, s39, 0
    s_add_u32 s45, s39, 23552
    buffer_load_dwordx4 v4, s[16:19], s44 offen lds
    buffer_load_dwordx4 v4, s[16:19], s45 offen offset:1024 lds
    s_add_u32 m0, s51, 122880
    s_add_u32 s44, s39, 1024
    s_add_u32 s45, s39, 24576
    buffer_load_dwordx4 v4, s[16:19], s44 offen lds
    buffer_load_dwordx4 v4, s[16:19], s45 offen offset:1024 lds
    s_waitcnt vmcnt(12)
    s_barrier
    s_add_u32 m0, s51, 131072
    s_add_u32 s44, s40, 0
    s_add_u32 s45, s40, 23552
    buffer_load_dwordx4 v4, s[16:19], s44 offen lds
    buffer_load_dwordx4 v4, s[16:19], s45 offen offset:1024 lds
    s_add_u32 m0, s51, 139264
    s_add_u32 s44, s40, 1024
    s_add_u32 s45, s40, 24576
    buffer_load_dwordx4 v4, s[16:19], s44 offen lds
    buffer_load_dwordx4 v4, s[16:19], s45 offen offset:1024 lds
    s_add_u32 m0, s51, 147456
    s_add_u32 s44, s41, 0
    s_add_u32 s45, s41, 23552
    buffer_load_dwordx4 v4, s[16:19], s44 offen lds
    buffer_load_dwordx4 v4, s[16:19], s45 offen offset:1024 lds
    s_add_u32 m0, s51, 155648
    s_add_u32 s44, s41, 1024
    s_add_u32 s45, s41, 24576
    buffer_load_dwordx4 v4, s[16:19], s44 offen lds
    buffer_load_dwordx4 v4, s[16:19], s45 offen offset:1024 lds
    s_waitcnt vmcnt(16)
    s_barrier
    s_waitcnt vmcnt(12)
    s_barrier
    s_add_u32 m0, s51, 65536
    s_add_u32 s44, s42, 0
    s_add_u32 s45, s42, 23552
    buffer_load_dwordx4 v4, s[16:19], s44 offen lds
    buffer_load_dwordx4 v4, s[16:19], s45 offen offset:1024 lds
    s_add_u32 m0, s51, 73728
    s_add_u32 s44, s42, 1024
    s_add_u32 s45, s42, 24576
    buffer_load_dwordx4 v4, s[16:19], s44 offen lds
    buffer_load_dwordx4 v4, s[16:19], s45 offen offset:1024 lds
    s_waitcnt vmcnt(12)
    s_barrier
    s_add_u32 m0, s51, 81920
    s_add_u32 s44, s43, 0
    s_add_u32 s45, s43, 23552
    buffer_load_dwordx4 v4, s[16:19], s44 offen lds
    buffer_load_dwordx4 v4, s[16:19], s45 offen offset:1024 lds
    s_add_u32 m0, s51, 90112
    s_add_u32 s44, s43, 1024
    s_add_u32 s45, s43, 24576
    buffer_load_dwordx4 v4, s[16:19], s44 offen lds
    buffer_load_dwordx4 v4, s[16:19], s45 offen offset:1024 lds
    s_waitcnt vmcnt(12)
    s_barrier
    s_add_u32 m0, s51, 98304
    s_add_u32 s44, s36, 2048
    s_add_u32 s45, s36, 25600
    buffer_load_dwordx4 v4, s[16:19], s44 offen lds
    buffer_load_dwordx4 v4, s[16:19], s45 offen offset:1024 lds
    s_add_u32 m0, s51, 106496
    s_add_u32 s44, s37, 2048
    s_add_u32 s45, s37, 25600
    buffer_load_dwordx4 v4, s[16:19], s44 offen lds
    buffer_load_dwordx4 v4, s[16:19], s45 offen offset:1024 lds
    s_waitcnt vmcnt(12)
    s_barrier
    s_add_u32 m0, s51, 114688
    s_add_u32 s44, s38, 2048
    s_add_u32 s45, s38, 25600
    buffer_load_dwordx4 v4, s[16:19], s44 offen lds
    buffer_load_dwordx4 v4, s[16:19], s45 offen offset:1024 lds
    s_add_u32 m0, s51, 122880
    s_add_u32 s44, s39, 2048
    s_add_u32 s45, s39, 25600
    buffer_load_dwordx4 v4, s[16:19], s44 offen lds
    buffer_load_dwordx4 v4, s[16:19], s45 offen offset:1024 lds
    s_waitcnt vmcnt(12)
    s_barrier
    s_add_u32 m0, s51, 131072
    s_add_u32 s44, s40, 2048
    s_add_u32 s45, s40, 25600
    buffer_load_dwordx4 v4, s[16:19], s44 offen lds
    buffer_load_dwordx4 v4, s[16:19], s45 offen offset:1024 lds
    s_add_u32 m0, s51, 139264
    s_add_u32 s44, s41, 2048
    s_add_u32 s45, s41, 25600
    buffer_load_dwordx4 v4, s[16:19], s44 offen lds
    buffer_load_dwordx4 v4, s[16:19], s45 offen offset:1024 lds
    s_waitcnt vmcnt(12)
    s_barrier
    s_add_u32 m0, s51, 147456
    s_add_u32 s44, s42, 2048
    s_add_u32 s45, s42, 25600
    buffer_load_dwordx4 v4, s[16:19], s44 offen lds
    buffer_load_dwordx4 v4, s[16:19], s45 offen offset:1024 lds
    s_add_u32 m0, s51, 155648
    s_add_u32 s44, s43, 2048
    s_add_u32 s45, s43, 25600
    buffer_load_dwordx4 v4, s[16:19], s44 offen lds
    buffer_load_dwordx4 v4, s[16:19], s45 offen offset:1024 lds
    s_waitcnt vmcnt(12)
    s_barrier
    s_waitcnt vmcnt(8)
    s_barrier
    s_waitcnt vmcnt(4)
    s_barrier
    s_waitcnt vmcnt(0)
    s_barrier
k1_qkv_kernel_end:
    s_endpgm

.globl k2_main_kernel
.p2align 8
.type k2_main_kernel,@function
k2_main_kernel:
    s_cmp_ge_u32 s2, 256
    s_cbranch_scc1 k2_main_kernel_end
    s_load_dwordx16 s[4:19], s[0:1], 0
    s_load_dwordx2 s[20:21], s[0:1], 72
    v_lshrrev_b32 v1, 6, v0
    v_and_b32 v0, 63, v0
    v_readfirstlane_b32 s36, v1
    s_and_b32 s37, s2, 7
    s_lshr_b32 s38, s2, 3
    s_lshl_b32 s44, s37, 2
    s_and_b32 s45, s38, 3
    s_add_u32 s39, s44, s45
    s_lshr_b32 s40, s38, 2
    s_lshl_b32 s45, s45, 1
    s_add_u32 s43, s40, s45
    s_and_b32 s43, s43, 7
    s_lshl_b32 s44, s37, 1
    s_and_b32 s45, s38, 1
    s_add_u32 s41, s44, s45
    s_lshr_b32 s42, s38, 1
    v_lshlrev_b32 v2, 4, v0
    v_lshrrev_b32 v124, 5, v0
    s_mov_b32 s50, 0xffff0000
    s_lshl_b32 s44, s37, 2
    s_lshr_b32 s45, s38, 3
    s_add_u32 s51, s44, s45
    s_and_b32 s52, s38, 7
    s_lshl_b32 s59, s51, 16
    s_cmp_ge_u32 s36, 8
    s_cbranch_scc1 k2_main_kernel_ldr
    s_lshl_b32 s45, s36, 10
    s_add_u32 s60, s59, s45
    s_lshl_b32 s46, s52, 13
    s_add_u32 s61, s60, s46
    s_add_u32 s61, s61, 0
    s_add_u32 s46, s60, 2097152
    s_add_u32 s47, s60, 4194304
    s_mov_b32 m0, s45
    s_add_u32 s48, s45, 65536
    s_add_u32 s49, s59, 2097152
    s_waitcnt lgkmcnt(0)
    s_mov_b32 s24, s20
    s_mov_b32 s25, s21
    s_mov_b32 s26, 19070976
    s_mov_b32 s27, 0x00020000
    s_mov_b32 s62, s45
    s_mov_b32 s63, s46
    s_mov_b32 m0, s62
    buffer_load_dwordx4 v[4:7], v2, s[24:27], s61 offen
    buffer_load_dwordx4 v[108:111], v2, s[24:27], s49 offen
    buffer_load_dwordx4 v2, s[24:27], s63 offen  lds
    s_mov_b32 m0, s48
    s_nop 0
    buffer_load_dwordx4 v2, s[24:27], s47 offen  lds
    v_and_b32 v100, 1, v0
    v_add_u32 v100, -1, v100
    v_and_b32 v96, 0x3f803f80, v100
    v_mov_b32 v97, v96
    v_mov_b32 v98, v96
    v_mov_b32 v99, v96
    v_add_u32 v3, s45, v2
    v_add_u32 v3, 131072, v3
    ds_write_b128 v3, v[96:99]
    ds_write_b128 v3, v[96:99] offset:4096
    v_and_b32 v101, 15, v0
    v_lshlrev_b32 v101, 4, v101
    v_lshl_add_u32 v101, v124, 8, v101
    v_add_u32 v101, 65536, v101
    v_and_b32 v102, 16, v0
    v_cmp_eq_u32 vcc, 0, v102
    v_and_b32 v103, 11, v0
    v_min_u32 v103, 1, v103
    v_lshlrev_b32 v103, 4, v103
    v_add_u32 v103, 131072, v103
    v_mov_b32 v104, 8192
    v_cndmask_b32 v105, v103, v101, vcc
    v_cndmask_b32 v94, 0, v104, vcc
    v_mov_b32 v106, 143360
    v_mov_b32 v107, 1
    ds_write_b32 v106, v107
    v_mov_b32 v100, 155648
    v_mov_b32 v56, 0
    v_mov_b32 v57, 0
    v_mov_b32 v58, 0
    v_mov_b32 v59, 0
    ds_write_b128 v100, v[56:59]
    s_mov_b32 s53, 0
    s_mov_b32 s54, 1
    s_mov_b32 s56, 1
    s_mov_b32 s57, 99
    s_cmp_lt_u32 s36, 4
    s_cbranch_scc0 k2_main_kernel_young
    s_setprio 2
    s_mov_b32 s57, 6
    s_branch k2_main_kernel_prio
k2_main_kernel_young:
    s_setprio 1
k2_main_kernel_prio:
    v_mov_b32 v96, 0xff800000
    s_mov_b32 s55, 1
    s_waitcnt vmcnt(0) lgkmcnt(0)
    s_barrier
    s_branch k2_main_kernel_maxin
k2_main_kernel_maxpass:
    v_mov_b32 v92, v2
    v_mov_b32 v96, 0xff800000
    s_mov_b32 s55, 0
k2_main_kernel_maxloop:
    ds_read_b128 v[108:111], v92
    v_add_u32 v92, 1024, v92
    s_add_u32 s55, s55, 1
    s_waitcnt lgkmcnt(0)
k2_main_kernel_maxin:
    v_mfma_f32_32x32x16_bf16 v[24:39], v[108:111], v[4:7], 0
    v_mov_b32 v64, 0
    v_mov_b32 v65, 0
    v_mov_b32 v66, 0
    v_mov_b32 v67, 0
    v_mov_b32 v68, 0
    v_mov_b32 v69, 0
    v_mov_b32 v70, 0
    v_mov_b32 v71, 0
    v_mov_b32 v72, 0
    v_mov_b32 v73, 0
    v_mov_b32 v74, 0
    v_mov_b32 v75, 0
    v_mov_b32 v76, 0
    v_mov_b32 v77, 0
    v_mov_b32 v78, 0
    v_mov_b32 v79, 0
    v_max3_f32 v96, v24, v25, v96
    v_max3_f32 v96, v26, v27, v96
    v_max3_f32 v96, v28, v29, v96
    v_max3_f32 v96, v30, v31, v96
    v_max3_f32 v96, v32, v33, v96
    v_max3_f32 v96, v34, v35, v96
    v_max3_f32 v96, v36, v37, v96
    v_max3_f32 v96, v38, v39, v96
    s_cmp_lt_u32 s55, s54
    s_cbranch_scc1 k2_main_kernel_maxloop
    v_mov_b32 v97, v96
    v_mov_b32 v92, v2
    v_mov_b32 v93, v105
    v_permlane32_swap_b32 v96, v97
    s_cmp_eq_u32 s53, 0
    s_cbranch_scc1 k2_main_kernel_havek
    ds_read_b128 v[108:111], v92
    s_waitcnt lgkmcnt(0)
k2_main_kernel_havek:
    ds_read_b128 v[80:83], v92 offset:1024
    ds_read_b128 v[88:91], v3
    ds_read_b128 v[84:87], v93
    v_max_f32 v96, v96, v97
    v_sub_f32 v8, 0, v96
    v_sub_f32 v9, 0, v96
    v_sub_f32 v10, 0, v96
    v_sub_f32 v11, 0, v96
    v_sub_f32 v12, 0, v96
    v_sub_f32 v13, 0, v96
    v_sub_f32 v14, 0, v96
    v_sub_f32 v15, 0, v96
    v_sub_f32 v16, 0, v96
    v_sub_f32 v17, 0, v96
    v_sub_f32 v18, 0, v96
    v_sub_f32 v19, 0, v96
    v_sub_f32 v20, 0, v96
    v_sub_f32 v21, 0, v96
    v_sub_f32 v22, 0, v96
    v_sub_f32 v23, 0, v96
    v_mov_b32 v60, 0
    v_mov_b32 v61, 0
    v_mov_b32 v62, 0
    v_mov_b32 v63, 0
    v_mfma_f32_32x32x16_bf16 v[24:39], v[108:111], v[4:7], v[8:23]
    s_mov_b32 s55, 0
    s_mov_b32 s58, 2
    s_nop 7
    .p2align 6
k2_main_kernel_loop:
    s_waitcnt lgkmcnt(0)
    v_mfma_f32_32x32x16_bf16 v[40:55], v[80:83], v[4:7], v[8:23]
    ds_read_b128 v[80:83], v92 offset:2048
    v_exp_f32 v24, v24
    v_exp_f32 v25, v25
    v_exp_f32 v26, v26
    v_exp_f32 v27, v27
    v_mfma_f32_32x32x16_bf16 v[64:79], v[88:91], v[60:63], v[64:79]
    ds_read_b128 v[88:91], v93 offset:512
    v_exp_f32 v28, v28
    v_exp_f32 v29, v29
    v_exp_f32 v30, v30
    v_exp_f32 v31, v31
    v_cvt_pk_bf16_f32 v56, v24, v25
    v_cvt_pk_bf16_f32 v57, v26, v27
    v_cvt_pk_bf16_f32 v58, v28, v29
    v_cvt_pk_bf16_f32 v59, v30, v31
    v_exp_f32 v32, v32
    v_exp_f32 v33, v33
    v_mfma_f32_32x32x16_bf16 v[64:79], v[84:87], v[56:59], v[64:79]
    ds_read_b128 v[84:87], v93 offset:1024
    v_exp_f32 v34, v34
    v_exp_f32 v35, v35
    v_exp_f32 v36, v36
    v_exp_f32 v37, v37
    v_exp_f32 v38, v38
    v_exp_f32 v39, v39
    v_cvt_pk_bf16_f32 v60, v32, v33
    v_cvt_pk_bf16_f32 v61, v34, v35
    v_cvt_pk_bf16_f32 v62, v36, v37
    v_cvt_pk_bf16_f32 v63, v38, v39
    s_waitcnt lgkmcnt(0)
    v_mfma_f32_32x32x16_bf16 v[24:39], v[80:83], v[4:7], v[8:23]
    ds_read_b128 v[80:83], v92 offset:3072
    v_exp_f32 v40, v40
    v_exp_f32 v41, v41
    v_exp_f32 v42, v42
    v_exp_f32 v43, v43
    v_mfma_f32_32x32x16_bf16 v[64:79], v[88:91], v[60:63], v[64:79]
    ds_read_b128 v[88:91], v93 offset:1536
    v_exp_f32 v44, v44
    v_exp_f32 v45, v45
    v_exp_f32 v46, v46
    v_exp_f32 v47, v47
    v_cvt_pk_bf16_f32 v56, v40, v41
    v_cvt_pk_bf16_f32 v57, v42, v43
    v_cvt_pk_bf16_f32 v58, v44, v45
    v_cvt_pk_bf16_f32 v59, v46, v47
    v_exp_f32 v48, v48
    v_exp_f32 v49, v49
    v_mfma_f32_32x32x16_bf16 v[64:79], v[84:87], v[56:59], v[64:79]
    ds_read_b128 v[84:87], v93 offset:2048
    v_exp_f32 v50, v50
    v_exp_f32 v51, v51
    v_exp_f32 v52, v52
    v_exp_f32 v53, v53
    v_exp_f32 v54, v54
    v_exp_f32 v55, v55
    v_cvt_pk_bf16_f32 v60, v48, v49
    v_cvt_pk_bf16_f32 v61, v50, v51
    v_cvt_pk_bf16_f32 v62, v52, v53
    v_cvt_pk_bf16_f32 v63, v54, v55
    s_waitcnt lgkmcnt(0)
    v_mfma_f32_32x32x16_bf16 v[40:55], v[80:83], v[4:7], v[8:23]
    ds_read_b128 v[80:83], v92 offset:4096
    v_exp_f32 v24, v24
    v_exp_f32 v25, v25
    v_exp_f32 v26, v26
    v_exp_f32 v27, v27
    v_mfma_f32_32x32x16_bf16 v[64:79], v[88:91], v[60:63], v[64:79]
    ds_read_b128 v[88:91], v93 offset:2560
    v_exp_f32 v28, v28
    v_exp_f32 v29, v29
    v_exp_f32 v30, v30
    v_exp_f32 v31, v31
    v_cvt_pk_bf16_f32 v56, v24, v25
    v_cvt_pk_bf16_f32 v57, v26, v27
    v_cvt_pk_bf16_f32 v58, v28, v29
    v_cvt_pk_bf16_f32 v59, v30, v31
    v_exp_f32 v32, v32
    v_exp_f32 v33, v33
    v_mfma_f32_32x32x16_bf16 v[64:79], v[84:87], v[56:59], v[64:79]
    ds_read_b128 v[84:87], v93 offset:3072
    v_exp_f32 v34, v34
    v_exp_f32 v35, v35
    v_exp_f32 v36, v36
    v_exp_f32 v37, v37
    v_exp_f32 v38, v38
    v_exp_f32 v39, v39
    v_cvt_pk_bf16_f32 v60, v32, v33
    v_cvt_pk_bf16_f32 v61, v34, v35
    v_cvt_pk_bf16_f32 v62, v36, v37
    v_cvt_pk_bf16_f32 v63, v38, v39
    s_waitcnt lgkmcnt(0)
    v_mfma_f32_32x32x16_bf16 v[24:39], v[80:83], v[4:7], v[8:23]
    ds_read_b128 v[80:83], v92 offset:5120
    v_exp_f32 v40, v40
    v_exp_f32 v41, v41
    v_exp_f32 v42, v42
    v_exp_f32 v43, v43
    v_mfma_f32_32x32x16_bf16 v[64:79], v[88:91], v[60:63], v[64:79]
    ds_read_b128 v[88:91], v93 offset:3584
    v_exp_f32 v44, v44
    v_exp_f32 v45, v45
    v_exp_f32 v46, v46
    v_exp_f32 v47, v47
    v_cvt_pk_bf16_f32 v56, v40, v41
    v_cvt_pk_bf16_f32 v57, v42, v43
    v_cvt_pk_bf16_f32 v58, v44, v45
    v_cvt_pk_bf16_f32 v59, v46, v47
    v_exp_f32 v48, v48
    v_exp_f32 v49, v49
    v_mfma_f32_32x32x16_bf16 v[64:79], v[84:87], v[56:59], v[64:79]
    ds_read_b128 v[84:87], v93 offset:4096
    v_exp_f32 v50, v50
    v_exp_f32 v51, v51
    v_exp_f32 v52, v52
    v_exp_f32 v53, v53
    v_exp_f32 v54, v54
    v_exp_f32 v55, v55
    v_cvt_pk_bf16_f32 v60, v48, v49
    v_cvt_pk_bf16_f32 v61, v50, v51
    v_cvt_pk_bf16_f32 v62, v52, v53
    v_cvt_pk_bf16_f32 v63, v54, v55
    s_waitcnt lgkmcnt(0)
    v_mfma_f32_32x32x16_bf16 v[40:55], v[80:83], v[4:7], v[8:23]
    ds_read_b128 v[80:83], v92 offset:6144
    v_exp_f32 v24, v24
    v_exp_f32 v25, v25
    v_exp_f32 v26, v26
    v_exp_f32 v27, v27
    v_mfma_f32_32x32x16_bf16 v[64:79], v[88:91], v[60:63], v[64:79]
    ds_read_b128 v[88:91], v93 offset:4608
    v_exp_f32 v28, v28
    v_exp_f32 v29, v29
    v_exp_f32 v30, v30
    v_exp_f32 v31, v31
    v_cvt_pk_bf16_f32 v56, v24, v25
    v_cvt_pk_bf16_f32 v57, v26, v27
    v_cvt_pk_bf16_f32 v58, v28, v29
    v_cvt_pk_bf16_f32 v59, v30, v31
    v_exp_f32 v32, v32
    v_exp_f32 v33, v33
    v_mfma_f32_32x32x16_bf16 v[64:79], v[84:87], v[56:59], v[64:79]
    ds_read_b128 v[84:87], v93 offset:5120
    v_exp_f32 v34, v34
    v_exp_f32 v35, v35
    v_exp_f32 v36, v36
    v_exp_f32 v37, v37
    v_exp_f32 v38, v38
    v_exp_f32 v39, v39
    v_cvt_pk_bf16_f32 v60, v32, v33
    v_cvt_pk_bf16_f32 v61, v34, v35
    v_cvt_pk_bf16_f32 v62, v36, v37
    v_cvt_pk_bf16_f32 v63, v38, v39
    s_cmp_eq_u32 s55, s57
    s_cbranch_scc0 k2_main_kernel_keepprio
    s_setprio 0
k2_main_kernel_keepprio:
    s_waitcnt lgkmcnt(0)
    v_mfma_f32_32x32x16_bf16 v[24:39], v[80:83], v[4:7], v[8:23]
    ds_read_b128 v[80:83], v92 offset:7168
    v_exp_f32 v40, v40
    v_exp_f32 v41, v41
    v_exp_f32 v42, v42
    v_exp_f32 v43, v43
    v_mfma_f32_32x32x16_bf16 v[64:79], v[88:91], v[60:63], v[64:79]
    ds_read_b128 v[88:91], v93 offset:5632
    v_exp_f32 v44, v44
    v_exp_f32 v45, v45
    v_exp_f32 v46, v46
    v_exp_f32 v47, v47
    v_cvt_pk_bf16_f32 v56, v40, v41
    v_cvt_pk_bf16_f32 v57, v42, v43
    v_cvt_pk_bf16_f32 v58, v44, v45
    v_cvt_pk_bf16_f32 v59, v46, v47
    v_exp_f32 v48, v48
    v_exp_f32 v49, v49
    v_mfma_f32_32x32x16_bf16 v[64:79], v[84:87], v[56:59], v[64:79]
    ds_read_b128 v[84:87], v93 offset:6144
    v_exp_f32 v50, v50
    v_exp_f32 v51, v51
    v_exp_f32 v52, v52
    v_exp_f32 v53, v53
    v_exp_f32 v54, v54
    v_exp_f32 v55, v55
    v_cvt_pk_bf16_f32 v60, v48, v49
    v_cvt_pk_bf16_f32 v61, v50, v51
    v_cvt_pk_bf16_f32 v62, v52, v53
    v_cvt_pk_bf16_f32 v63, v54, v55
    s_cmp_lt_u32 s56, s58
    s_cbranch_scc1 k2_main_kernel_sync
k2_main_kernel_syncret:
    s_waitcnt lgkmcnt(0)
    v_mfma_f32_32x32x16_bf16 v[40:55], v[80:83], v[4:7], v[8:23]
    ds_read_b128 v[80:83], v92 offset:8192
    v_exp_f32 v24, v24
    v_exp_f32 v25, v25
    v_exp_f32 v26, v26
    v_exp_f32 v27, v27
    v_mfma_f32_32x32x16_bf16 v[64:79], v[88:91], v[60:63], v[64:79]
    ds_read_b128 v[88:91], v93 offset:6656
    v_exp_f32 v28, v28
    v_exp_f32 v29, v29
    v_exp_f32 v30, v30
    v_exp_f32 v31, v31
    v_cvt_pk_bf16_f32 v56, v24, v25
    v_cvt_pk_bf16_f32 v57, v26, v27
    v_cvt_pk_bf16_f32 v58, v28, v29
    v_cvt_pk_bf16_f32 v59, v30, v31
    v_exp_f32 v32, v32
    v_exp_f32 v33, v33
    v_mfma_f32_32x32x16_bf16 v[64:79], v[84:87], v[56:59], v[64:79]
    ds_read_b128 v[84:87], v93 offset:7168
    v_exp_f32 v34, v34
    v_exp_f32 v35, v35
    v_exp_f32 v36, v36
    v_exp_f32 v37, v37
    v_exp_f32 v38, v38
    v_exp_f32 v39, v39
    v_cvt_pk_bf16_f32 v60, v32, v33
    v_cvt_pk_bf16_f32 v61, v34, v35
    v_cvt_pk_bf16_f32 v62, v36, v37
    v_cvt_pk_bf16_f32 v63, v38, v39
    s_waitcnt lgkmcnt(0)
    v_mfma_f32_32x32x16_bf16 v[24:39], v[80:83], v[4:7], v[8:23]
    ds_read_b128 v[80:83], v92 offset:9216
    v_exp_f32 v40, v40
    v_exp_f32 v41, v41
    v_exp_f32 v42, v42
    v_exp_f32 v43, v43
    v_mfma_f32_32x32x16_bf16 v[64:79], v[88:91], v[60:63], v[64:79]
    ds_read_b128 v[88:91], v93 offset:7680
    v_exp_f32 v44, v44
    v_exp_f32 v45, v45
    v_exp_f32 v46, v46
    v_exp_f32 v47, v47
    v_cvt_pk_bf16_f32 v56, v40, v41
    v_cvt_pk_bf16_f32 v57, v42, v43
    v_cvt_pk_bf16_f32 v58, v44, v45
    v_cvt_pk_bf16_f32 v59, v46, v47
    v_exp_f32 v48, v48
    v_exp_f32 v49, v49
    v_mfma_f32_32x32x16_bf16 v[64:79], v[84:87], v[56:59], v[64:79]
    ds_read_b128 v[84:87], v93 offset:8192
    v_exp_f32 v50, v50
    v_exp_f32 v51, v51
    v_exp_f32 v52, v52
    v_exp_f32 v53, v53
    v_exp_f32 v54, v54
    v_exp_f32 v55, v55
    v_cvt_pk_bf16_f32 v60, v48, v49
    v_cvt_pk_bf16_f32 v61, v50, v51
    v_cvt_pk_bf16_f32 v62, v52, v53
    v_cvt_pk_bf16_f32 v63, v54, v55
    v_add_u32 v92, 8192, v92
    v_add_u32 v93, v94, v93
    s_add_u32 s58, s58, 1
    s_min_u32 s58, s58, 8
    s_add_u32 s55, s55, 1
    s_cmp_lt_u32 s55, 8
    s_cbranch_scc1 k2_main_kernel_loop
    s_waitcnt lgkmcnt(0)
    v_mfma_f32_32x32x16_bf16 v[64:79], v[88:91], v[60:63], v[64:79]
    s_lshl_b32 s44, s52, 3
    s_add_u32 s44, s44, s36
    s_lshl_b32 s44, s44, 5
    s_add_u32 s44, s44, s51
    s_lshl_b32 s44, s44, 10
    s_add_u32 s44, s44, 6291456
    s_mov_b32 s46, 0x53800000
    s_nop 7
    v_cmp_ngt_f32 vcc, s46, v72
    v_rcp_f32 v96, v72
    s_cmp_eq_u32 s53, 0
    s_cbranch_scc0 k2_main_kernel_ostore
    s_cbranch_vccz k2_main_kernel_ostore
    s_mov_b32 s53, 1
    s_mov_b32 s54, 64
    s_branch k2_main_kernel_maxpass
k2_main_kernel_sync:
    ds_read_b32 v107, v106
    s_waitcnt lgkmcnt(0)
    v_readfirstlane_b32 s56, v107
    s_nop 0
    s_cmp_lt_u32 s56, s58
    s_cbranch_scc1 k2_main_kernel_sync
    s_branch k2_main_kernel_syncret
k2_main_kernel_ostore:
    v_mul_f32 v64, v64, v96
    v_mul_f32 v65, v65, v96
    v_mul_f32 v66, v66, v96
    v_mul_f32 v67, v67, v96
    v_mul_f32 v68, v68, v96
    v_mul_f32 v69, v69, v96
    v_mul_f32 v70, v70, v96
    v_mul_f32 v71, v71, v96
    v_cvt_pk_bf16_f32 v56, v64, v65
    v_cvt_pk_bf16_f32 v57, v66, v67
    v_cvt_pk_bf16_f32 v58, v68, v69
    v_cvt_pk_bf16_f32 v59, v70, v71
    buffer_store_dwordx4 v[56:59], v2, s[24:27], s44 offen sc1
    s_setprio 0
    v_mov_b32 v3, 155656
    v_mov_b32 v4, 1
    s_lshl_b32 s44, s2, 7
    s_add_u32 s44, s44, 19005440
    s_mov_b64 exec, 1
    s_waitcnt vmcnt(0)
    ds_add_rtn_u32 v7, v3, v4
    v_mov_b32 v3, 0
    s_waitcnt lgkmcnt(0)
    v_mov_b32 v4, 1
    v_readfirstlane_b32 s45, v7
    s_nop 0
    s_cmp_eq_u32 s45, 8
    s_cbranch_scc0 k2_main_kernel_ns2
    buffer_store_dword v4, v3, s[24:27], s44 offen sc1
k2_main_kernel_ns2:
    s_mov_b64 exec, -1
    s_barrier
    s_and_b32 s53, s36, 3
    s_lshr_b32 s54, s36, 2
    s_lshl_b32 s44, s39, 1
    s_add_u32 s55, s44, s54
    s_lshl_b32 s56, s55, 15
    s_lshl_b32 s44, s53, 13
    s_add_u32 s56, s56, s44
    s_add_u32 s56, s56, 6291456
    s_add_u32 s57, s56, 4096
    s_cmp_lg_u32 s36, 4
    s_cbranch_scc1 k2_main_kernel_np2
    v_lshrrev_b32 v3, 3, v0
    v_lshlrev_b32 v3, 3, v3
    v_add_u32 v3, s37, v3
    v_lshlrev_b32 v3, 3, v3
    v_and_b32 v4, 7, v0
    v_add_u32 v3, v3, v4
    v_lshlrev_b32 v3, 7, v3
    s_mov_b32 exec_lo, 0xffffffff
    s_mov_b32 exec_hi, 0
    s_mov_b32 s45, 262144
    s_mov_b32 s44, 19005440
    s_mov_b32 s46, 19070976
    s_mov_b64 s[62:63], -1
k2_main_kernel_pl2:
    buffer_load_dword v89, v3, s[24:27], s44 offen sc1
    s_sub_u32 s45, s45, 1
    s_waitcnt vmcnt(0)
    v_cmp_ne_u32 vcc, 1, v89
    s_cmp_eq_u32 s45, 0
    s_cbranch_scc1 k2_main_kernel_pd2
    s_nop 2
    s_and_b64 s[62:63], vcc, exec
    s_cbranch_scc1 k2_main_kernel_pl2
k2_main_kernel_pd2:
    s_mov_b64 exec, -1
k2_main_kernel_np2:
    s_barrier
    buffer_load_dwordx4 v[56:59], v2, s[24:27], s56 offen offset:0 sc1
    buffer_load_dwordx4 v[60:63], v2, s[24:27], s56 offen offset:1024 sc1
    buffer_load_dwordx4 v[64:67], v2, s[24:27], s56 offen offset:2048 sc1
    buffer_load_dwordx4 v[68:71], v2, s[24:27], s56 offen offset:3072 sc1
    buffer_load_dwordx4 v[72:75], v2, s[24:27], s57 offen offset:0 sc1
    buffer_load_dwordx4 v[76:79], v2, s[24:27], s57 offen offset:1024 sc1
    buffer_load_dwordx4 v[80:83], v2, s[24:27], s57 offen offset:2048 sc1
    buffer_load_dwordx4 v[84:87], v2, s[24:27], s57 offen offset:3072 sc1
    s_mul_i32 s59, s53, 16384
    s_add_u32 s59, s59, 81920
    v_bfe_u32 v116, v0, 2, 2
    v_lshl_add_u32 v117, v124, 2, v116
    v_lshlrev_b32 v5, 7, v117
    v_lshrrev_b32 v116, 1, v116
    v_lshlrev_b32 v116, 1, v116
    v_bfe_u32 v117, v0, 4, 1
    v_or_b32 v116, v116, v117
    v_xor_b32 v116, s53, v116
    v_lshl_add_u32 v5, v116, 5, v5
    v_and_b32 v116, 3, v0
    v_lshl_add_u32 v5, v116, 3, v5
    v_add_u32 v5, s59, v5
    v_xor_b32 v6, 64, v5
    ds_read_b64_tr_b16 v[44:45], v6 offset:0
    ds_read_b64_tr_b16 v[46:47], v6 offset:1024
    ds_read_b64_tr_b16 v[40:41], v5 offset:0
    ds_read_b64_tr_b16 v[42:43], v5 offset:1024
    s_xor_b32 s44, s36, 0
    s_lshl_b32 s44, s44, 13
    s_add_u32 s44, s44, 16384
    v_add_u32 v1, s44, v2
    s_xor_b32 s44, s36, 1
    s_lshl_b32 s44, s44, 13
    s_add_u32 s44, s44, 16384
    v_add_u32 v117, s44, v2
    s_xor_b32 s44, s36, 2
    s_lshl_b32 s44, s44, 13
    s_add_u32 s44, s44, 16384
    v_add_u32 v118, s44, v2
    s_xor_b32 s44, s36, 3
    s_lshl_b32 s44, s44, 13
    s_add_u32 s44, s44, 16384
    v_add_u32 v119, s44, v2
    v_and_b32 v3, 31, v0
    v_bfe_u32 v4, v0, 1, 3
    s_lshl_b32 s45, s53, 1
    v_xor_b32 v4, s45, v4
    v_lshlrev_b32 v3, 7, v3
    v_lshl_add_u32 v3, v4, 4, v3
    v_lshl_add_u32 v3, v124, 3, v3
    s_lshl_b32 s45, s54, 12
    s_add_u32 s45, s45, 147456
    v_add_u32 v3, s45, v3
    v_xor_b32 v4, 16, v3
    s_lshl_b32 s44, s55, 5
    s_lshl_b32 s45, s40, 2
    s_add_u32 s44, s44, s45
    s_add_u32 s44, s44, s53
    s_lshl_b32 s61, s44, 10
    s_add_u32 s61, s61, 8388608
    s_lshl_b32 s62, s44, 8
    s_add_u32 s62, s62, 10485760
    v_and_b32 v7, 31, v0
    v_lshlrev_b32 v7, 3, v7
    s_waitcnt vmcnt(7) lgkmcnt(0)
    v_mfma_f32_32x32x16_bf16 v[24:39], v[44:47], v[56:59], 0
    ds_read_b64_tr_b16 v[52:53], v6 offset:2048
    ds_read_b64_tr_b16 v[54:55], v6 offset:3072
    v_mfma_f32_32x32x16_bf16 v[8:23], v[40:43], v[56:59], 0
    ds_read_b64_tr_b16 v[48:49], v5 offset:2048
    ds_read_b64_tr_b16 v[50:51], v5 offset:3072
    s_waitcnt vmcnt(6) lgkmcnt(0)
    v_mfma_f32_32x32x16_bf16 v[24:39], v[52:55], v[60:63], v[24:39]
    ds_read_b64_tr_b16 v[44:45], v6 offset:4096
    ds_read_b64_tr_b16 v[46:47], v6 offset:5120
    v_mfma_f32_32x32x16_bf16 v[8:23], v[48:51], v[60:63], v[8:23]
    ds_read_b64_tr_b16 v[40:41], v5 offset:4096
    ds_read_b64_tr_b16 v[42:43], v5 offset:5120
    s_waitcnt vmcnt(5) lgkmcnt(0)
    v_mfma_f32_32x32x16_bf16 v[24:39], v[44:47], v[64:67], v[24:39]
    ds_read_b64_tr_b16 v[52:53], v6 offset:6144
    ds_read_b64_tr_b16 v[54:55], v6 offset:7168
    v_mfma_f32_32x32x16_bf16 v[8:23], v[40:43], v[64:67], v[8:23]
    ds_read_b64_tr_b16 v[48:49], v5 offset:6144
    ds_read_b64_tr_b16 v[50:51], v5 offset:7168
    s_waitcnt vmcnt(4) lgkmcnt(0)
    v_mfma_f32_32x32x16_bf16 v[24:39], v[52:55], v[68:71], v[24:39]
    ds_read_b64_tr_b16 v[44:45], v6 offset:8192
    ds_read_b64_tr_b16 v[46:47], v6 offset:9216
    v_mfma_f32_32x32x16_bf16 v[8:23], v[48:51], v[68:71], v[8:23]
    ds_read_b64_tr_b16 v[40:41], v5 offset:8192
    ds_read_b64_tr_b16 v[42:43], v5 offset:9216
    s_waitcnt vmcnt(3) lgkmcnt(0)
    v_mfma_f32_32x32x16_bf16 v[24:39], v[44:47], v[72:75], v[24:39]
    ds_read_b64_tr_b16 v[52:53], v6 offset:10240
    ds_read_b64_tr_b16 v[54:55], v6 offset:11264
    v_mfma_f32_32x32x16_bf16 v[8:23], v[40:43], v[72:75], v[8:23]
    ds_read_b64_tr_b16 v[48:49], v5 offset:10240
    ds_read_b64_tr_b16 v[50:51], v5 offset:11264
    s_waitcnt vmcnt(2) lgkmcnt(0)
    v_mfma_f32_32x32x16_bf16 v[24:39], v[52:55], v[76:79], v[24:39]
    ds_read_b64_tr_b16 v[44:45], v6 offset:12288
    ds_read_b64_tr_b16 v[46:47], v6 offset:13312
    v_mfma_f32_32x32x16_bf16 v[8:23], v[48:51], v[76:79], v[8:23]
    ds_read_b64_tr_b16 v[40:41], v5 offset:12288
    ds_read_b64_tr_b16 v[42:43], v5 offset:13312
    s_waitcnt vmcnt(1) lgkmcnt(0)
    v_mfma_f32_32x32x16_bf16 v[24:39], v[44:47], v[80:83], v[24:39]
    ds_read_b64_tr_b16 v[52:53], v6 offset:14336
    ds_read_b64_tr_b16 v[54:55], v6 offset:15360
    v_mfma_f32_32x32x16_bf16 v[8:23], v[40:43], v[80:83], v[8:23]
    ds_read_b64_tr_b16 v[48:49], v5 offset:14336
    ds_read_b64_tr_b16 v[50:51], v5 offset:15360
    s_waitcnt vmcnt(0) lgkmcnt(0)
    v_mfma_f32_32x32x16_bf16 v[24:39], v[52:55], v[84:87], v[24:39]
    ds_read_b64 v[112:113], v3
    v_mfma_f32_32x32x16_bf16 v[8:23], v[48:51], v[84:87], v[8:23]
    ds_read_b64 v[114:115], v4
    s_nop 7
    s_nop 3
    ds_write_b128 v1, v[32:35] offset:6144
    ds_write_b128 v1, v[36:39] offset:7168
    ds_write_b128 v1, v[24:27] offset:4096
    ds_write_b128 v1, v[28:31] offset:5120
    ds_write_b128 v1, v[16:19] offset:2048
    ds_write_b128 v1, v[20:23] offset:3072
    s_waitcnt lgkmcnt(6)
    v_lshlrev_b32 v40, 16, v112
    v_and_b32 v41, s50, v112
    v_lshlrev_b32 v42, 16, v113
    v_and_b32 v43, s50, v113
    v_lshlrev_b32 v44, 16, v114
    v_and_b32 v45, s50, v114
    v_lshlrev_b32 v46, 16, v115
    v_and_b32 v47, s50, v115
    v_add_f32 v8, v8, v40
    v_add_f32 v9, v9, v41
    v_add_f32 v10, v10, v42
    v_add_f32 v11, v11, v43
    v_add_f32 v12, v12, v44
    v_add_f32 v13, v13, v45
    v_add_f32 v14, v14, v46
    v_add_f32 v15, v15, v47
    s_waitcnt lgkmcnt(0)
    s_barrier
    ds_read_b128 v[88:91], v117 offset:2048
    ds_read_b128 v[92:95], v117 offset:3072
    ds_read_b128 v[96:99], v118 offset:4096
    ds_read_b128 v[100:103], v118 offset:5120
    ds_read_b128 v[104:107], v119 offset:6144
    ds_read_b128 v[108:111], v119 offset:7168
    s_waitcnt lgkmcnt(2)
    v_add_f32 v88, v88, v96
    v_add_f32 v89, v89, v97
    v_add_f32 v90, v90, v98
    v_add_f32 v91, v91, v99
    v_add_f32 v92, v92, v100
    v_add_f32 v93, v93, v101
    v_add_f32 v94, v94, v102
    v_add_f32 v95, v95, v103
    s_waitcnt lgkmcnt(0)
    v_add_f32 v8, v8, v104
    v_add_f32 v9, v9, v105
    v_add_f32 v10, v10, v106
    v_add_f32 v11, v11, v107
    v_add_f32 v12, v12, v108
    v_add_f32 v13, v13, v109
    v_add_f32 v14, v14, v110
    v_add_f32 v15, v15, v111
    v_add_f32 v8, v8, v88
    v_add_f32 v9, v9, v89
    v_add_f32 v10, v10, v90
    v_add_f32 v11, v11, v91
    v_add_f32 v12, v12, v92
    v_add_f32 v13, v13, v93
    v_add_f32 v14, v14, v94
    v_add_f32 v15, v15, v95
    v_cvt_pk_bf16_f32 v120, v8, v9
    v_cvt_pk_bf16_f32 v121, v10, v11
    v_cvt_pk_bf16_f32 v122, v12, v13
    v_cvt_pk_bf16_f32 v123, v14, v15
    buffer_store_dwordx4 v[120:123], v2, s[24:27], s61 offen sc1
    v_lshlrev_b32 v40, 16, v120
    v_and_b32 v41, s50, v120
    v_lshlrev_b32 v42, 16, v121
    v_and_b32 v43, s50, v121
    v_lshlrev_b32 v44, 16, v122
    v_and_b32 v45, s50, v122
    v_lshlrev_b32 v46, 16, v123
    v_and_b32 v47, s50, v123
    v_add_f32 v24, v40, v41
    v_mul_f32 v25, v40, v40
    v_add_f32 v26, v42, v43
    v_mul_f32 v27, v41, v41
    v_fmac_f32 v25, v42, v42
    v_fmac_f32 v27, v43, v43
    v_add_f32 v24, v24, v44
    v_fmac_f32 v25, v44, v44
    v_add_f32 v26, v26, v45
    v_fmac_f32 v27, v45, v45
    v_add_f32 v24, v24, v46
    v_fmac_f32 v25, v46, v46
    v_add_f32 v26, v26, v47
    v_fmac_f32 v27, v47, v47
    v_add_f32 v24, v24, v26
    v_add_f32 v25, v25, v27
    v_mov_b32 v26, v24
    v_mov_b32 v27, v25
    s_nop 1
    v_permlane32_swap_b32 v24, v26
    v_permlane32_swap_b32 v25, v27
    s_nop 1
    v_add_f32 v24, v24, v26
    v_add_f32 v25, v25, v27
    buffer_store_dwordx2 v[24:25], v7, s[24:27], s62 offen sc1
    s_barrier
    v_mov_b32 v3, 155648
    v_mov_b32 v4, 1
    s_lshl_b32 s44, s2, 7
    s_add_u32 s44, s44, 18874368
    s_mov_b64 exec, 1
    s_waitcnt vmcnt(0)
    ds_add_rtn_u32 v7, v3, v4
    v_mov_b32 v3, 0
    s_waitcnt lgkmcnt(0)
    v_mov_b32 v4, 1
    v_readfirstlane_b32 s45, v7
    s_nop 0
    s_cmp_eq_u32 s45, 7
    s_cbranch_scc0 k2_main_kernel_ns3
    s_add_u32 s46, s44, 65536
    buffer_store_dword v4, v3, s[24:27], s46 offen
    buffer_store_dword v4, v3, s[24:27], s44 offen sc1
k2_main_kernel_ns3:
    s_mov_b64 exec, -1
    s_cmp_ge_u32 s38, 28
    s_cbranch_scc1 k2_main_kernel_skip4
    s_cmp_lg_u32 s36, 4
    s_cbranch_scc1 k2_main_kernel_p4
    v_lshrrev_b32 v3, 1, v0
    v_lshlrev_b32 v3, 2, v3
    v_and_b32 v4, 1, v0
    v_add_u32 v3, v3, v4
    s_and_b32 s44, s38, 1
    s_lshl_b32 s44, s44, 1
    v_add_u32 v3, s44, v3
    v_lshlrev_b32 v3, 3, v3
    v_add_u32 v3, s37, v3
    v_lshlrev_b32 v3, 7, v3
    s_mov_b32 exec_lo, 0xffff
    s_mov_b32 exec_hi, 0
    s_mov_b32 s45, 262144
    s_mov_b32 s44, 18874368
    s_mov_b32 s46, 18939904
    s_mov_b64 s[62:63], -1
k2_main_kernel_pl3:
    buffer_load_dword v88, v3, s[24:27], s46 offen sc1
    s_waitcnt vmcnt(0)
    v_cmp_ne_u32 vcc, 1, v88
    s_nop 3
    s_and_b64 vcc, vcc, s[62:63]
    s_cbranch_scc0 k2_main_kernel_pd3
    buffer_load_dword v88, v3, s[24:27], s46 offen sc1
    s_waitcnt vmcnt(0)
    v_cmp_ne_u32 vcc, 1, v88
    s_nop 3
    s_and_b64 vcc, vcc, s[62:63]
    s_cbranch_scc0 k2_main_kernel_pd3
    buffer_load_dword v88, v3, s[24:27], s46 offen sc1
    s_waitcnt vmcnt(0)
    v_cmp_ne_u32 vcc, 1, v88
    s_nop 3
    s_and_b64 vcc, vcc, s[62:63]
    s_cbranch_scc0 k2_main_kernel_pd3
    buffer_load_dword v88, v3, s[24:27], s46 offen sc1
    s_waitcnt vmcnt(0)
    v_cmp_ne_u32 vcc, 1, v88
    s_nop 3
    s_and_b64 vcc, vcc, s[62:63]
    s_cbranch_scc0 k2_main_kernel_pd3
    buffer_load_dword v88, v3, s[24:27], s46 offen sc1
    s_waitcnt vmcnt(0)
    v_cmp_ne_u32 vcc, 1, v88
    s_nop 3
    s_and_b64 vcc, vcc, s[62:63]
    s_cbranch_scc0 k2_main_kernel_pd3
    buffer_load_dword v88, v3, s[24:27], s46 offen sc1
    s_waitcnt vmcnt(0)
    v_cmp_ne_u32 vcc, 1, v88
    s_nop 3
    s_and_b64 vcc, vcc, s[62:63]
    s_cbranch_scc0 k2_main_kernel_pd3
    buffer_load_dword v88, v3, s[24:27], s46 offen sc1
    s_waitcnt vmcnt(0)
    v_cmp_ne_u32 vcc, 1, v88
    s_nop 3
    s_and_b64 vcc, vcc, s[62:63]
    s_cbranch_scc0 k2_main_kernel_pd3
    buffer_load_dword v88, v3, s[24:27], s46 offen sc1
    s_waitcnt vmcnt(0)
    v_cmp_ne_u32 vcc, 1, v88
    s_nop 3
    s_and_b64 vcc, vcc, s[62:63]
    s_cbranch_scc0 k2_main_kernel_pd3
    buffer_load_dword v89, v3, s[24:27], s44 offen sc1
    s_sub_u32 s45, s45, 1
    s_waitcnt vmcnt(0)
    v_cmp_ne_u32 vcc, 1, v89
    s_cmp_eq_u32 s45, 0
    s_cbranch_scc1 k2_main_kernel_pd3
    s_nop 2
    s_and_b64 s[62:63], vcc, exec
    s_cbranch_scc1 k2_main_kernel_pl3
k2_main_kernel_pd3:
    s_mov_b64 exec, -1
    s_barrier
    s_branch k2_main_kernel_p4s
k2_main_kernel_p4:
    s_barrier
k2_main_kernel_p4s:
    s_and_b32 s51, s36, 1
    s_lshr_b32 s52, s36, 1
    v_bfe_u32 v76, v0, 2, 2
    v_lshl_add_u32 v77, v124, 2, v76
    v_lshlrev_b32 v84, 7, v77
    v_lshrrev_b32 v76, 1, v76
    s_and_b32 s44, s52, 1
    v_xor_b32 v76, s44, v76
    v_lshl_add_u32 v84, v76, 6, v84
    v_bfe_u32 v76, v0, 4, 1
    v_lshl_add_u32 v84, v76, 5, v84
    v_and_b32 v76, 3, v0
    v_lshl_add_u32 v84, v76, 3, v84
    s_lshr_b32 s44, s52, 1
    s_lshl_b32 s44, s44, 12
    v_add_u32 v84, s44, v84
    v_add_u32 v85, 65536, v84
    v_add_u32 v86, 131072, v84
    s_lshl_b32 s44, s51, 12
    v_add_u32 v87, s44, v2
    v_add_u32 v88, 65536, v87
    v_add_u32 v89, 131072, v87
    s_lshl_b32 s44, s41, 2
    s_lshl_b32 s45, s51, 1
    s_add_u32 s44, s44, s45
    s_mul_i32 s56, s44, 114688
    s_lshl_b32 s45, s42, 13
    s_add_u32 s56, s56, s45
    s_lshl_b32 s45, s52, 11
    s_add_u32 s56, s56, s45
    s_add_u32 s56, s56, 11534336
    s_add_u32 s57, s56, 114688
    s_lshl_b32 s44, s52, 10
    s_add_u32 s44, s44, 147456
    v_add_u32 v4, s44, v2
    s_lshl_b32 s44, s51, 11
    s_add_u32 s44, s44, 151552
    v_add_u32 v5, s44, v2
    s_lshl_b32 s44, s51, 9
    s_add_u32 s44, s44, 156672
    v_lshlrev_b32 v6, 2, v0
    v_add_u32 v6, s44, v6
    s_barrier
    ds_read_b64_tr_b16 v[40:41], v84 offset:0
    ds_read_b64_tr_b16 v[42:43], v84 offset:1024
    ds_read_b128 v[44:47], v88 offset:24576
    ds_read_b128 v[48:51], v88 offset:26624
    ds_read_b64_tr_b16 v[52:53], v84 offset:2048
    ds_read_b64_tr_b16 v[54:55], v84 offset:3072
    ds_read_b128 v[56:59], v88 offset:25600
    ds_read_b128 v[60:63], v88 offset:27648
    s_barrier
    s_waitcnt lgkmcnt(4)
    v_mfma_f32_32x32x16_bf16 v[8:23], v[40:43], v[44:47], 0
    ds_read_b64_tr_b16 v[64:65], v84 offset:8192
    ds_read_b64_tr_b16 v[66:67], v84 offset:9216
    v_mfma_f32_32x32x16_bf16 v[24:39], v[40:43], v[48:51], 0
    ds_read_b128 v[68:71], v88 offset:32768
    ds_read_b128 v[72:75], v88 offset:34816
    s_waitcnt lgkmcnt(4)
    v_mfma_f32_32x32x16_bf16 v[8:23], v[52:55], v[56:59], v[8:23]
    ds_read_b64_tr_b16 v[40:41], v84 offset:10240
    ds_read_b64_tr_b16 v[42:43], v84 offset:11264
    v_mfma_f32_32x32x16_bf16 v[24:39], v[52:55], v[60:63], v[24:39]
    ds_read_b128 v[44:47], v88 offset:33792
    ds_read_b128 v[48:51], v88 offset:35840
    s_barrier
    s_waitcnt lgkmcnt(4)
    v_mfma_f32_32x32x16_bf16 v[8:23], v[64:67], v[68:71], v[8:23]
    ds_read_b64_tr_b16 v[52:53], v84 offset:16384
    ds_read_b64_tr_b16 v[54:55], v84 offset:17408
    v_mfma_f32_32x32x16_bf16 v[24:39], v[64:67], v[72:75], v[24:39]
    ds_read_b128 v[56:59], v88 offset:40960
    ds_read_b128 v[60:63], v88 offset:43008
    s_waitcnt lgkmcnt(4)
    v_mfma_f32_32x32x16_bf16 v[8:23], v[40:43], v[44:47], v[8:23]
    ds_read_b64_tr_b16 v[64:65], v84 offset:18432
    ds_read_b64_tr_b16 v[66:67], v84 offset:19456
    v_mfma_f32_32x32x16_bf16 v[24:39], v[40:43], v[48:51], v[24:39]
    ds_read_b128 v[68:71], v88 offset:41984
    ds_read_b128 v[72:75], v88 offset:44032
    s_waitcnt lgkmcnt(4)
    v_mfma_f32_32x32x16_bf16 v[8:23], v[52:55], v[56:59], v[8:23]
    ds_read_b64_tr_b16 v[40:41], v84 offset:24576
    ds_read_b64_tr_b16 v[42:43], v84 offset:25600
    v_mfma_f32_32x32x16_bf16 v[24:39], v[52:55], v[60:63], v[24:39]
    ds_read_b128 v[44:47], v88 offset:49152
    ds_read_b128 v[48:51], v88 offset:51200
    s_waitcnt lgkmcnt(4)
    v_mfma_f32_32x32x16_bf16 v[8:23], v[64:67], v[68:71], v[8:23]
    ds_read_b64_tr_b16 v[52:53], v84 offset:26624
    ds_read_b64_tr_b16 v[54:55], v84 offset:27648
    v_mfma_f32_32x32x16_bf16 v[24:39], v[64:67], v[72:75], v[24:39]
    ds_read_b128 v[56:59], v88 offset:50176
    ds_read_b128 v[60:63], v88 offset:52224
    s_barrier
    s_waitcnt lgkmcnt(4)
    v_mfma_f32_32x32x16_bf16 v[8:23], v[40:43], v[44:47], v[8:23]
    ds_read_b64_tr_b16 v[64:65], v84 offset:32768
    ds_read_b64_tr_b16 v[66:67], v84 offset:33792
    v_mfma_f32_32x32x16_bf16 v[24:39], v[40:43], v[48:51], v[24:39]
    ds_read_b128 v[68:71], v88 offset:57344
    ds_read_b128 v[72:75], v88 offset:59392
    s_waitcnt lgkmcnt(4)
    v_mfma_f32_32x32x16_bf16 v[8:23], v[52:55], v[56:59], v[8:23]
    ds_read_b64_tr_b16 v[40:41], v84 offset:34816
    ds_read_b64_tr_b16 v[42:43], v84 offset:35840
    v_mfma_f32_32x32x16_bf16 v[24:39], v[52:55], v[60:63], v[24:39]
    ds_read_b128 v[44:47], v88 offset:58368
    ds_read_b128 v[48:51], v88 offset:60416
    s_waitcnt lgkmcnt(4)
    v_mfma_f32_32x32x16_bf16 v[8:23], v[64:67], v[68:71], v[8:23]
    ds_read_b64_tr_b16 v[52:53], v84 offset:40960
    ds_read_b64_tr_b16 v[54:55], v84 offset:41984
    v_mfma_f32_32x32x16_bf16 v[24:39], v[64:67], v[72:75], v[24:39]
    ds_read_b128 v[56:59], v89 offset:0
    ds_read_b128 v[60:63], v89 offset:2048
    s_waitcnt lgkmcnt(4)
    v_mfma_f32_32x32x16_bf16 v[8:23], v[40:43], v[44:47], v[8:23]
    ds_read_b64_tr_b16 v[64:65], v84 offset:43008
    ds_read_b64_tr_b16 v[66:67], v84 offset:44032
    v_mfma_f32_32x32x16_bf16 v[24:39], v[40:43], v[48:51], v[24:39]
    ds_read_b128 v[68:71], v89 offset:1024
    ds_read_b128 v[72:75], v89 offset:3072
    s_barrier
    s_waitcnt lgkmcnt(4)
    v_mfma_f32_32x32x16_bf16 v[8:23], v[52:55], v[56:59], v[8:23]
    ds_read_b64_tr_b16 v[40:41], v84 offset:49152
    ds_read_b64_tr_b16 v[42:43], v84 offset:50176
    v_mfma_f32_32x32x16_bf16 v[24:39], v[52:55], v[60:63], v[24:39]
    ds_read_b128 v[44:47], v89 offset:8192
    ds_read_b128 v[48:51], v89 offset:10240
    s_waitcnt lgkmcnt(4)
    v_mfma_f32_32x32x16_bf16 v[8:23], v[64:67], v[68:71], v[8:23]
    ds_read_b64_tr_b16 v[52:53], v84 offset:51200
    ds_read_b64_tr_b16 v[54:55], v84 offset:52224
    v_mfma_f32_32x32x16_bf16 v[24:39], v[64:67], v[72:75], v[24:39]
    ds_read_b128 v[56:59], v89 offset:9216
    ds_read_b128 v[60:63], v89 offset:11264
    s_waitcnt lgkmcnt(4)
    v_mfma_f32_32x32x16_bf16 v[8:23], v[40:43], v[44:47], v[8:23]
    ds_read_b64_tr_b16 v[64:65], v84 offset:57344
    ds_read_b64_tr_b16 v[66:67], v84 offset:58368
    v_mfma_f32_32x32x16_bf16 v[24:39], v[40:43], v[48:51], v[24:39]
    ds_read_b128 v[68:71], v87 offset:0
    ds_read_b128 v[72:75], v87 offset:2048
    s_waitcnt lgkmcnt(4)
    v_mfma_f32_32x32x16_bf16 v[8:23], v[52:55], v[56:59], v[8:23]
    ds_read_b64_tr_b16 v[40:41], v84 offset:59392
    ds_read_b64_tr_b16 v[42:43], v84 offset:60416
    v_mfma_f32_32x32x16_bf16 v[24:39], v[52:55], v[60:63], v[24:39]
    ds_read_b128 v[44:47], v87 offset:1024
    ds_read_b128 v[48:51], v87 offset:3072
    s_barrier
    s_waitcnt lgkmcnt(4)
    v_mfma_f32_32x32x16_bf16 v[8:23], v[64:67], v[68:71], v[8:23]
    ds_read_b64_tr_b16 v[52:53], v85 offset:0
    ds_read_b64_tr_b16 v[54:55], v85 offset:1024
    v_mfma_f32_32x32x16_bf16 v[24:39], v[64:67], v[72:75], v[24:39]
    ds_read_b128 v[56:59], v87 offset:8192
    ds_read_b128 v[60:63], v87 offset:10240
    s_waitcnt lgkmcnt(4)
    v_mfma_f32_32x32x16_bf16 v[8:23], v[40:43], v[44:47], v[8:23]
    ds_read_b64_tr_b16 v[64:65], v85 offset:2048
    ds_read_b64_tr_b16 v[66:67], v85 offset:3072
    v_mfma_f32_32x32x16_bf16 v[24:39], v[40:43], v[48:51], v[24:39]
    ds_read_b128 v[68:71], v87 offset:9216
    ds_read_b128 v[72:75], v87 offset:11264
    s_waitcnt lgkmcnt(4)
    v_mfma_f32_32x32x16_bf16 v[8:23], v[52:55], v[56:59], v[8:23]
    ds_read_b64_tr_b16 v[40:41], v85 offset:8192
    ds_read_b64_tr_b16 v[42:43], v85 offset:9216
    v_mfma_f32_32x32x16_bf16 v[24:39], v[52:55], v[60:63], v[24:39]
    ds_read_b128 v[44:47], v87 offset:16384
    ds_read_b128 v[48:51], v87 offset:18432
    s_waitcnt lgkmcnt(4)
    v_mfma_f32_32x32x16_bf16 v[8:23], v[64:67], v[68:71], v[8:23]
    ds_read_b64_tr_b16 v[52:53], v85 offset:10240
    ds_read_b64_tr_b16 v[54:55], v85 offset:11264
    v_mfma_f32_32x32x16_bf16 v[24:39], v[64:67], v[72:75], v[24:39]
    ds_read_b128 v[56:59], v87 offset:17408
    ds_read_b128 v[60:63], v87 offset:19456
    s_barrier
    s_waitcnt lgkmcnt(4)
    v_mfma_f32_32x32x16_bf16 v[8:23], v[40:43], v[44:47], v[8:23]
    ds_read_b64_tr_b16 v[64:65], v85 offset:16384
    ds_read_b64_tr_b16 v[66:67], v85 offset:17408
    v_mfma_f32_32x32x16_bf16 v[24:39], v[40:43], v[48:51], v[24:39]
    ds_read_b128 v[68:71], v87 offset:24576
    ds_read_b128 v[72:75], v87 offset:26624
    s_waitcnt lgkmcnt(4)
    v_mfma_f32_32x32x16_bf16 v[8:23], v[52:55], v[56:59], v[8:23]
    ds_read_b64_tr_b16 v[40:41], v85 offset:18432
    ds_read_b64_tr_b16 v[42:43], v85 offset:19456
    v_mfma_f32_32x32x16_bf16 v[24:39], v[52:55], v[60:63], v[24:39]
    ds_read_b128 v[44:47], v87 offset:25600
    ds_read_b128 v[48:51], v87 offset:27648
    s_waitcnt lgkmcnt(4)
    v_mfma_f32_32x32x16_bf16 v[8:23], v[64:67], v[68:71], v[8:23]
    ds_read_b64_tr_b16 v[52:53], v85 offset:24576
    ds_read_b64_tr_b16 v[54:55], v85 offset:25600
    v_mfma_f32_32x32x16_bf16 v[24:39], v[64:67], v[72:75], v[24:39]
    ds_read_b128 v[56:59], v87 offset:32768
    ds_read_b128 v[60:63], v87 offset:34816
    s_waitcnt lgkmcnt(4)
    v_mfma_f32_32x32x16_bf16 v[8:23], v[40:43], v[44:47], v[8:23]
    ds_read_b64_tr_b16 v[64:65], v85 offset:26624
    ds_read_b64_tr_b16 v[66:67], v85 offset:27648
    v_mfma_f32_32x32x16_bf16 v[24:39], v[40:43], v[48:51], v[24:39]
    ds_read_b128 v[68:71], v87 offset:33792
    ds_read_b128 v[72:75], v87 offset:35840
    s_barrier
    s_waitcnt lgkmcnt(4)
    v_mfma_f32_32x32x16_bf16 v[8:23], v[52:55], v[56:59], v[8:23]
    ds_read_b64_tr_b16 v[40:41], v85 offset:32768
    ds_read_b64_tr_b16 v[42:43], v85 offset:33792
    v_mfma_f32_32x32x16_bf16 v[24:39], v[52:55], v[60:63], v[24:39]
    ds_read_b128 v[44:47], v87 offset:40960
    ds_read_b128 v[48:51], v87 offset:43008
    s_waitcnt lgkmcnt(4)
    v_mfma_f32_32x32x16_bf16 v[8:23], v[64:67], v[68:71], v[8:23]
    ds_read_b64_tr_b16 v[52:53], v85 offset:34816
    ds_read_b64_tr_b16 v[54:55], v85 offset:35840
    v_mfma_f32_32x32x16_bf16 v[24:39], v[64:67], v[72:75], v[24:39]
    ds_read_b128 v[56:59], v87 offset:41984
    ds_read_b128 v[60:63], v87 offset:44032
    s_waitcnt lgkmcnt(4)
    v_mfma_f32_32x32x16_bf16 v[8:23], v[40:43], v[44:47], v[8:23]
    ds_read_b64_tr_b16 v[64:65], v85 offset:40960
    ds_read_b64_tr_b16 v[66:67], v85 offset:41984
    v_mfma_f32_32x32x16_bf16 v[24:39], v[40:43], v[48:51], v[24:39]
    ds_read_b128 v[68:71], v89 offset:0
    ds_read_b128 v[72:75], v89 offset:2048
    s_waitcnt lgkmcnt(4)
    v_mfma_f32_32x32x16_bf16 v[8:23], v[52:55], v[56:59], v[8:23]
    ds_read_b64_tr_b16 v[40:41], v85 offset:43008
    ds_read_b64_tr_b16 v[42:43], v85 offset:44032
    v_mfma_f32_32x32x16_bf16 v[24:39], v[52:55], v[60:63], v[24:39]
    ds_read_b128 v[44:47], v89 offset:1024
    ds_read_b128 v[48:51], v89 offset:3072
    s_barrier
    s_waitcnt lgkmcnt(4)
    v_mfma_f32_32x32x16_bf16 v[8:23], v[64:67], v[68:71], v[8:23]
    ds_read_b64_tr_b16 v[52:53], v85 offset:49152
    ds_read_b64_tr_b16 v[54:55], v85 offset:50176
    v_mfma_f32_32x32x16_bf16 v[24:39], v[64:67], v[72:75], v[24:39]
    ds_read_b128 v[56:59], v87 offset:49152
    ds_read_b128 v[60:63], v87 offset:51200
    s_waitcnt lgkmcnt(4)
    v_mfma_f32_32x32x16_bf16 v[8:23], v[40:43], v[44:47], v[8:23]
    ds_read_b64_tr_b16 v[64:65], v85 offset:51200
    ds_read_b64_tr_b16 v[66:67], v85 offset:52224
    v_mfma_f32_32x32x16_bf16 v[24:39], v[40:43], v[48:51], v[24:39]
    ds_read_b128 v[68:71], v87 offset:50176
    ds_read_b128 v[72:75], v87 offset:52224
    s_waitcnt lgkmcnt(4)
    v_mfma_f32_32x32x16_bf16 v[8:23], v[52:55], v[56:59], v[8:23]
    ds_read_b64_tr_b16 v[40:41], v85 offset:57344
    ds_read_b64_tr_b16 v[42:43], v85 offset:58368
    v_mfma_f32_32x32x16_bf16 v[24:39], v[52:55], v[60:63], v[24:39]
    ds_read_b128 v[44:47], v89 offset:8192
    ds_read_b128 v[48:51], v89 offset:10240
    s_waitcnt lgkmcnt(4)
    v_mfma_f32_32x32x16_bf16 v[8:23], v[64:67], v[68:71], v[8:23]
    ds_read_b64_tr_b16 v[52:53], v85 offset:59392
    ds_read_b64_tr_b16 v[54:55], v85 offset:60416
    v_mfma_f32_32x32x16_bf16 v[24:39], v[64:67], v[72:75], v[24:39]
    ds_read_b128 v[56:59], v89 offset:9216
    ds_read_b128 v[60:63], v89 offset:11264
    s_waitcnt lgkmcnt(4)
    v_mfma_f32_32x32x16_bf16 v[8:23], v[40:43], v[44:47], v[8:23]
    ds_read_b128 v[64:67], v4
    ds_read_b128 v[68:71], v5
    v_mfma_f32_32x32x16_bf16 v[24:39], v[40:43], v[48:51], v[24:39]
    ds_read_b128 v[72:75], v5 offset:1024
    ds_read2_b32 v[96:97], v6 offset0:0 offset1:64
    s_waitcnt lgkmcnt(4)
    v_mfma_f32_32x32x16_bf16 v[8:23], v[52:55], v[56:59], v[8:23]
    v_mfma_f32_32x32x16_bf16 v[24:39], v[52:55], v[60:63], v[24:39]
    s_waitcnt lgkmcnt(0)
    s_barrier
    v_mfma_f32_32x32x16_bf16 v[8:23], v[64:67], v[68:71], v[8:23]
    v_mfma_f32_32x32x16_bf16 v[24:39], v[64:67], v[72:75], v[24:39]
    v_mul_f32 v92, 0x3fb8aa3b, v96
    v_mul_f32 v94, -2.0, v96
    v_mul_f32 v93, 0x3fb8aa3b, v97
    v_mul_f32 v95, -2.0, v97
    s_nop 7
    v_mul_f32 v76, v92, v8
    v_mul_f32 v77, v92, v9
    v_mul_f32 v78, v92, v10
    v_mul_f32 v79, v92, v11
    v_mul_f32 v80, v92, v12
    v_mul_f32 v81, v92, v13
    v_mul_f32 v82, v92, v14
    v_mul_f32 v83, v92, v15
    s_setprio 1
    v_exp_f32 v76, v76
    v_exp_f32 v77, v77
    v_exp_f32 v78, v78
    v_exp_f32 v79, v79
    v_exp_f32 v80, v80
    v_exp_f32 v81, v81
    v_exp_f32 v82, v82
    v_exp_f32 v83, v83
    s_setprio 0
    v_add_f32 v76, 1.0, v76
    v_add_f32 v77, 1.0, v77
    v_add_f32 v78, 1.0, v78
    v_add_f32 v79, 1.0, v79
    v_add_f32 v80, 1.0, v80
    v_add_f32 v81, 1.0, v81
    v_add_f32 v82, 1.0, v82
    v_add_f32 v83, 1.0, v83
    v_fma_f32 v76, v76, v76, 1.0
    v_fma_f32 v77, v77, v77, 1.0
    v_fma_f32 v78, v78, v78, 1.0
    v_fma_f32 v79, v79, v79, 1.0
    v_fma_f32 v80, v80, v80, 1.0
    v_fma_f32 v81, v81, v81, 1.0
    v_fma_f32 v82, v82, v82, 1.0
    v_fma_f32 v83, v83, v83, 1.0
    s_setprio 1
    v_rcp_f32 v76, v76
    v_rcp_f32 v77, v77
    v_rcp_f32 v78, v78
    v_rcp_f32 v79, v79
    v_rcp_f32 v80, v80
    v_rcp_f32 v81, v81
    v_rcp_f32 v82, v82
    v_rcp_f32 v83, v83
    s_setprio 0
    v_fma_f32 v76, v76, v94, v96
    v_fma_f32 v77, v77, v94, v96
    v_fma_f32 v78, v78, v94, v96
    v_fma_f32 v79, v79, v94, v96
    v_fma_f32 v80, v80, v94, v96
    v_fma_f32 v81, v81, v94, v96
    v_fma_f32 v82, v82, v94, v96
    v_fma_f32 v83, v83, v94, v96
    v_mul_f32 v8, v8, v76
    v_mul_f32 v9, v9, v77
    v_mul_f32 v10, v10, v78
    v_mul_f32 v11, v11, v79
    v_mul_f32 v12, v12, v80
    v_mul_f32 v13, v13, v81
    v_mul_f32 v14, v14, v82
    v_mul_f32 v15, v15, v83
    v_cvt_pk_bf16_f32 v8, v8, v9
    v_cvt_pk_bf16_f32 v9, v10, v11
    v_cvt_pk_bf16_f32 v10, v12, v13
    v_cvt_pk_bf16_f32 v11, v14, v15
    buffer_store_dwordx4 v[8:11], v2, s[24:27], s56 offen offset:0 sc1
    v_mul_f32 v76, v93, v24
    v_mul_f32 v77, v93, v25
    v_mul_f32 v78, v93, v26
    v_mul_f32 v79, v93, v27
    v_mul_f32 v80, v93, v28
    v_mul_f32 v81, v93, v29
    v_mul_f32 v82, v93, v30
    v_mul_f32 v83, v93, v31
    s_setprio 1
    v_exp_f32 v76, v76
    v_exp_f32 v77, v77
    v_exp_f32 v78, v78
    v_exp_f32 v79, v79
    v_exp_f32 v80, v80
    v_exp_f32 v81, v81
    v_exp_f32 v82, v82
    v_exp_f32 v83, v83
    s_setprio 0
    v_add_f32 v76, 1.0, v76
    v_add_f32 v77, 1.0, v77
    v_add_f32 v78, 1.0, v78
    v_add_f32 v79, 1.0, v79
    v_add_f32 v80, 1.0, v80
    v_add_f32 v81, 1.0, v81
    v_add_f32 v82, 1.0, v82
    v_add_f32 v83, 1.0, v83
    v_fma_f32 v76, v76, v76, 1.0
    v_fma_f32 v77, v77, v77, 1.0
    v_fma_f32 v78, v78, v78, 1.0
    v_fma_f32 v79, v79, v79, 1.0
    v_fma_f32 v80, v80, v80, 1.0
    v_fma_f32 v81, v81, v81, 1.0
    v_fma_f32 v82, v82, v82, 1.0
    v_fma_f32 v83, v83, v83, 1.0
    s_setprio 1
    v_rcp_f32 v76, v76
    v_rcp_f32 v77, v77
    v_rcp_f32 v78, v78
    v_rcp_f32 v79, v79
    v_rcp_f32 v80, v80
    v_rcp_f32 v81, v81
    v_rcp_f32 v82, v82
    v_rcp_f32 v83, v83
    s_setprio 0
    v_fma_f32 v76, v76, v95, v97
    v_fma_f32 v77, v77, v95, v97
    v_fma_f32 v78, v78, v95, v97
    v_fma_f32 v79, v79, v95, v97
    v_fma_f32 v80, v80, v95, v97
    v_fma_f32 v81, v81, v95, v97
    v_fma_f32 v82, v82, v95, v97
    v_fma_f32 v83, v83, v95, v97
    v_mul_f32 v24, v24, v76
    v_mul_f32 v25, v25, v77
    v_mul_f32 v26, v26, v78
    v_mul_f32 v27, v27, v79
    v_mul_f32 v28, v28, v80
    v_mul_f32 v29, v29, v81
    v_mul_f32 v30, v30, v82
    v_mul_f32 v31, v31, v83
    v_cvt_pk_bf16_f32 v24, v24, v25
    v_cvt_pk_bf16_f32 v25, v26, v27
    v_cvt_pk_bf16_f32 v26, v28, v29
    v_cvt_pk_bf16_f32 v27, v30, v31
    buffer_store_dwordx4 v[24:27], v2, s[24:27], s57 offen offset:0 sc1
    v_mul_f32 v76, v92, v16
    v_mul_f32 v77, v92, v17
    v_mul_f32 v78, v92, v18
    v_mul_f32 v79, v92, v19
    v_mul_f32 v80, v92, v20
    v_mul_f32 v81, v92, v21
    v_mul_f32 v82, v92, v22
    v_mul_f32 v83, v92, v23
    s_setprio 1
    v_exp_f32 v76, v76
    v_exp_f32 v77, v77
    v_exp_f32 v78, v78
    v_exp_f32 v79, v79
    v_exp_f32 v80, v80
    v_exp_f32 v81, v81
    v_exp_f32 v82, v82
    v_exp_f32 v83, v83
    s_setprio 0
    v_add_f32 v76, 1.0, v76
    v_add_f32 v77, 1.0, v77
    v_add_f32 v78, 1.0, v78
    v_add_f32 v79, 1.0, v79
    v_add_f32 v80, 1.0, v80
    v_add_f32 v81, 1.0, v81
    v_add_f32 v82, 1.0, v82
    v_add_f32 v83, 1.0, v83
    v_fma_f32 v76, v76, v76, 1.0
    v_fma_f32 v77, v77, v77, 1.0
    v_fma_f32 v78, v78, v78, 1.0
    v_fma_f32 v79, v79, v79, 1.0
    v_fma_f32 v80, v80, v80, 1.0
    v_fma_f32 v81, v81, v81, 1.0
    v_fma_f32 v82, v82, v82, 1.0
    v_fma_f32 v83, v83, v83, 1.0
    s_setprio 1
    v_rcp_f32 v76, v76
    v_rcp_f32 v77, v77
    v_rcp_f32 v78, v78
    v_rcp_f32 v79, v79
    v_rcp_f32 v80, v80
    v_rcp_f32 v81, v81
    v_rcp_f32 v82, v82
    v_rcp_f32 v83, v83
    s_setprio 0
    v_fma_f32 v76, v76, v94, v96
    v_fma_f32 v77, v77, v94, v96
    v_fma_f32 v78, v78, v94, v96
    v_fma_f32 v79, v79, v94, v96
    v_fma_f32 v80, v80, v94, v96
    v_fma_f32 v81, v81, v94, v96
    v_fma_f32 v82, v82, v94, v96
    v_fma_f32 v83, v83, v94, v96
    v_mul_f32 v16, v16, v76
    v_mul_f32 v17, v17, v77
    v_mul_f32 v18, v18, v78
    v_mul_f32 v19, v19, v79
    v_mul_f32 v20, v20, v80
    v_mul_f32 v21, v21, v81
    v_mul_f32 v22, v22, v82
    v_mul_f32 v23, v23, v83
    v_cvt_pk_bf16_f32 v16, v16, v17
    v_cvt_pk_bf16_f32 v17, v18, v19
    v_cvt_pk_bf16_f32 v18, v20, v21
    v_cvt_pk_bf16_f32 v19, v22, v23
    buffer_store_dwordx4 v[16:19], v2, s[24:27], s56 offen offset:1024 sc1
    v_mul_f32 v76, v93, v32
    v_mul_f32 v77, v93, v33
    v_mul_f32 v78, v93, v34
    v_mul_f32 v79, v93, v35
    v_mul_f32 v80, v93, v36
    v_mul_f32 v81, v93, v37
    v_mul_f32 v82, v93, v38
    v_mul_f32 v83, v93, v39
    s_setprio 1
    v_exp_f32 v76, v76
    v_exp_f32 v77, v77
    v_exp_f32 v78, v78
    v_exp_f32 v79, v79
    v_exp_f32 v80, v80
    v_exp_f32 v81, v81
    v_exp_f32 v82, v82
    v_exp_f32 v83, v83
    s_setprio 0
    v_add_f32 v76, 1.0, v76
    v_add_f32 v77, 1.0, v77
    v_add_f32 v78, 1.0, v78
    v_add_f32 v79, 1.0, v79
    v_add_f32 v80, 1.0, v80
    v_add_f32 v81, 1.0, v81
    v_add_f32 v82, 1.0, v82
    v_add_f32 v83, 1.0, v83
    v_fma_f32 v76, v76, v76, 1.0
    v_fma_f32 v77, v77, v77, 1.0
    v_fma_f32 v78, v78, v78, 1.0
    v_fma_f32 v79, v79, v79, 1.0
    v_fma_f32 v80, v80, v80, 1.0
    v_fma_f32 v81, v81, v81, 1.0
    v_fma_f32 v82, v82, v82, 1.0
    v_fma_f32 v83, v83, v83, 1.0
    s_setprio 1
    v_rcp_f32 v76, v76
    v_rcp_f32 v77, v77
    v_rcp_f32 v78, v78
    v_rcp_f32 v79, v79
    v_rcp_f32 v80, v80
    v_rcp_f32 v81, v81
    v_rcp_f32 v82, v82
    v_rcp_f32 v83, v83
    s_setprio 0
    v_fma_f32 v76, v76, v95, v97
    v_fma_f32 v77, v77, v95, v97
    v_fma_f32 v78, v78, v95, v97
    v_fma_f32 v79, v79, v95, v97
    v_fma_f32 v80, v80, v95, v97
    v_fma_f32 v81, v81, v95, v97
    v_fma_f32 v82, v82, v95, v97
    v_fma_f32 v83, v83, v95, v97
    v_mul_f32 v32, v32, v76
    v_mul_f32 v33, v33, v77
    v_mul_f32 v34, v34, v78
    v_mul_f32 v35, v35, v79
    v_mul_f32 v36, v36, v80
    v_mul_f32 v37, v37, v81
    v_mul_f32 v38, v38, v82
    v_mul_f32 v39, v39, v83
    v_cvt_pk_bf16_f32 v32, v32, v33
    v_cvt_pk_bf16_f32 v33, v34, v35
    v_cvt_pk_bf16_f32 v34, v36, v37
    v_cvt_pk_bf16_f32 v35, v38, v39
    buffer_store_dwordx4 v[32:35], v2, s[24:27], s57 offen offset:1024 sc1
    v_mov_b32 v3, 155652
    v_mov_b32 v4, 1
    s_lshl_b32 s44, s2, 7
    s_add_u32 s44, s44, 18907136
    s_mov_b64 exec, 1
    s_waitcnt vmcnt(2)
    ds_add_rtn_u32 v7, v3, v4
    v_mov_b32 v3, 0
    s_waitcnt lgkmcnt(0)
    v_mov_b32 v4, 1
    v_readfirstlane_b32 s45, v7
    s_nop 0
    s_cmp_eq_u32 s45, 7
    s_cbranch_scc0 k2_main_kernel_ns4
    s_add_u32 s46, s44, 65536
    buffer_store_dword v4, v3, s[24:27], s46 offen
    buffer_store_dword v4, v3, s[24:27], s44 offen sc1
k2_main_kernel_ns4:
    s_mov_b64 exec, -1
    v_mov_b32 v3, 155660
    v_mov_b32 v4, 1
    s_lshl_b32 s44, s2, 7
    s_add_u32 s44, s44, 18907140
    s_mov_b64 exec, 1
    s_waitcnt vmcnt(0)
    ds_add_rtn_u32 v7, v3, v4
    v_mov_b32 v3, 0
    s_waitcnt lgkmcnt(0)
    v_mov_b32 v4, 1
    v_readfirstlane_b32 s45, v7
    s_nop 0
    s_cmp_eq_u32 s45, 7
    s_cbranch_scc0 k2_main_kernel_ns4b
    s_add_u32 s46, s44, 65536
    buffer_store_dword v4, v3, s[24:27], s46 offen
    buffer_store_dword v4, v3, s[24:27], s44 offen sc1
k2_main_kernel_ns4b:
    s_mov_b64 exec, -1
    s_branch k2_main_kernel_p5
k2_main_kernel_skip4:
    s_mov_b32 s28, s16
    s_mov_b32 s29, s17
    s_mov_b32 s30, 1835008
    s_mov_b32 s31, 0x00020000
    s_sub_u32 s44, s38, 28
    s_lshl_b32 s44, s44, 3
    s_add_u32 s44, s44, s36
    s_mul_i32 s44, s44, 57344
    v_lshlrev_b32 v4, 7, v0
    s_add_u32 s45, s44, 0
    buffer_load_dword v8, v4, s[28:31], s45 offen
    s_add_u32 s45, s44, 8192
    buffer_load_dword v9, v4, s[28:31], s45 offen
    s_add_u32 s45, s44, 16384
    buffer_load_dword v10, v4, s[28:31], s45 offen
    s_add_u32 s45, s44, 24576
    buffer_load_dword v11, v4, s[28:31], s45 offen
    s_add_u32 s45, s44, 32768
    buffer_load_dword v12, v4, s[28:31], s45 offen
    s_add_u32 s45, s44, 40960
    buffer_load_dword v13, v4, s[28:31], s45 offen
    s_add_u32 s45, s44, 49152
    buffer_load_dword v14, v4, s[28:31], s45 offen
    s_waitcnt vmcnt(0)
    s_barrier
k2_main_kernel_p5:
    s_mul_i32 s59, s53, 38912
    s_add_u32 s59, s59, 0
    v_bfe_u32 v116, v0, 2, 2
    v_lshl_add_u32 v117, v124, 2, v116
    v_lshlrev_b32 v5, 7, v117
    v_lshrrev_b32 v116, 1, v116
    v_lshlrev_b32 v116, 1, v116
    v_bfe_u32 v117, v0, 4, 1
    v_or_b32 v116, v116, v117
    v_xor_b32 v116, s53, v116
    v_lshl_add_u32 v5, v116, 5, v5
    v_and_b32 v116, 3, v0
    v_lshl_add_u32 v5, v116, 3, v5
    v_add_u32 v5, s59, v5
    v_xor_b32 v6, 64, v5
    s_xor_b32 s44, s53, 0
    s_mul_i32 s44, s44, 38912
    s_lshl_b32 s45, s54, 13
    s_add_u32 s44, s44, s45
    s_add_u32 s44, s44, 18432
    v_add_u32 v1, s44, v2
    s_xor_b32 s44, s53, 1
    s_mul_i32 s44, s44, 38912
    s_lshl_b32 s45, s54, 13
    s_add_u32 s44, s44, s45
    s_add_u32 s44, s44, 18432
    v_add_u32 v117, s44, v2
    s_xor_b32 s44, s53, 2
    s_mul_i32 s44, s44, 38912
    s_lshl_b32 s45, s54, 13
    s_add_u32 s44, s44, s45
    s_add_u32 s44, s44, 18432
    v_add_u32 v118, s44, v2
    s_xor_b32 s44, s53, 3
    s_mul_i32 s44, s44, 38912
    s_lshl_b32 s45, s54, 13
    s_add_u32 s44, s44, s45
    s_add_u32 s44, s44, 18432
    v_add_u32 v119, s44, v2
    s_mov_b32 s32, s18
    s_mov_b32 s33, s19
    s_mov_b32 s34, 2097152
    s_mov_b32 s35, 0x00020000
    s_mul_i32 s51, s43, 7
    s_lshr_b32 s51, s51, 2
    s_mul_i32 s56, s55, 114688
    s_mul_i32 s44, s53, 28672
    s_add_u32 s56, s56, s44
    s_add_u32 s56, s56, 11534336
    v_and_b32 v7, 31, v0
    v_lshlrev_b32 v7, 10, v7
    v_lshl_add_u32 v7, v124, 4, v7
    s_lshl_b32 s61, s55, 15
    s_lshl_b32 s45, s40, 7
    s_add_u32 s61, s61, s45
    s_lshl_b32 s45, s53, 5
    s_add_u32 s61, s61, s45
    s_cmp_lg_u32 s36, 4
    s_cbranch_scc1 k2_main_kernel_p5a
    v_lshlrev_b32 v3, 1, v0
    s_bfe_u32 s44, s38, 0x10001
    v_add_u32 v3, s44, v3
    v_lshlrev_b32 v3, 3, v3
    v_add_u32 v3, s37, v3
    v_lshlrev_b32 v3, 7, v3
    s_mov_b32 exec_lo, 0x3fff
    s_mov_b32 exec_hi, 0
    s_mov_b32 s45, 262144
    s_mov_b32 s44, 18907136
    s_mov_b32 s46, 18972672
    s_mov_b64 s[62:63], -1
k2_main_kernel_pl4:
    buffer_load_dword v88, v3, s[24:27], s46 offen sc1
    s_waitcnt vmcnt(0)
    v_cmp_ne_u32 vcc, 1, v88
    s_nop 3
    s_and_b64 vcc, vcc, s[62:63]
    s_cbranch_scc0 k2_main_kernel_pd4
    buffer_load_dword v88, v3, s[24:27], s46 offen sc1
    s_waitcnt vmcnt(0)
    v_cmp_ne_u32 vcc, 1, v88
    s_nop 3
    s_and_b64 vcc, vcc, s[62:63]
    s_cbranch_scc0 k2_main_kernel_pd4
    buffer_load_dword v88, v3, s[24:27], s46 offen sc1
    s_waitcnt vmcnt(0)
    v_cmp_ne_u32 vcc, 1, v88
    s_nop 3
    s_and_b64 vcc, vcc, s[62:63]
    s_cbranch_scc0 k2_main_kernel_pd4
    buffer_load_dword v88, v3, s[24:27], s46 offen sc1
    s_waitcnt vmcnt(0)
    v_cmp_ne_u32 vcc, 1, v88
    s_nop 3
    s_and_b64 vcc, vcc, s[62:63]
    s_cbranch_scc0 k2_main_kernel_pd4
    buffer_load_dword v88, v3, s[24:27], s46 offen sc1
    s_waitcnt vmcnt(0)
    v_cmp_ne_u32 vcc, 1, v88
    s_nop 3
    s_and_b64 vcc, vcc, s[62:63]
    s_cbranch_scc0 k2_main_kernel_pd4
    buffer_load_dword v88, v3, s[24:27], s46 offen sc1
    s_waitcnt vmcnt(0)
    v_cmp_ne_u32 vcc, 1, v88
    s_nop 3
    s_and_b64 vcc, vcc, s[62:63]
    s_cbranch_scc0 k2_main_kernel_pd4
    buffer_load_dword v88, v3, s[24:27], s46 offen sc1
    s_waitcnt vmcnt(0)
    v_cmp_ne_u32 vcc, 1, v88
    s_nop 3
    s_and_b64 vcc, vcc, s[62:63]
    s_cbranch_scc0 k2_main_kernel_pd4
    buffer_load_dword v88, v3, s[24:27], s46 offen sc1
    s_waitcnt vmcnt(0)
    v_cmp_ne_u32 vcc, 1, v88
    s_nop 3
    s_and_b64 vcc, vcc, s[62:63]
    s_cbranch_scc0 k2_main_kernel_pd4
    buffer_load_dword v89, v3, s[24:27], s44 offen sc1
    s_sub_u32 s45, s45, 1
    s_waitcnt vmcnt(0)
    v_cmp_ne_u32 vcc, 1, v89
    s_cmp_eq_u32 s45, 0
    s_cbranch_scc1 k2_main_kernel_pd4
    s_nop 2
    s_and_b64 s[62:63], vcc, exec
    s_cbranch_scc1 k2_main_kernel_pl4
k2_main_kernel_pd4:
    s_mov_b64 exec, -1
k2_main_kernel_p5a:
    s_barrier
    s_lshl_b32 s44, s51, 11
    s_add_u32 s44, s44, s56
    buffer_load_dwordx4 v[56:59], v2, s[24:27], s44 offen offset:0 sc1
    s_add_u32 s51, s51, 1
    s_cmp_eq_u32 s51, 14
    s_cselect_b32 s51, 0, s51
    s_lshl_b32 s44, s51, 11
    s_add_u32 s44, s44, s56
    buffer_load_dwordx4 v[60:63], v2, s[24:27], s44 offen offset:0 sc1
    s_add_u32 s51, s51, 1
    s_cmp_eq_u32 s51, 14
    s_cselect_b32 s51, 0, s51
    s_lshl_b32 s44, s51, 11
    s_add_u32 s44, s44, s56
    buffer_load_dwordx4 v[64:67], v2, s[24:27], s44 offen offset:0 sc1
    s_add_u32 s51, s51, 1
    s_cmp_eq_u32 s51, 14
    s_cselect_b32 s51, 0, s51
    s_lshl_b32 s44, s51, 11
    s_add_u32 s44, s44, s56
    buffer_load_dwordx4 v[68:71], v2, s[24:27], s44 offen offset:0 sc1
    s_add_u32 s51, s51, 1
    s_cmp_eq_u32 s51, 14
    s_cselect_b32 s51, 0, s51
    s_lshl_b32 s44, s51, 11
    s_add_u32 s44, s44, s56
    buffer_load_dwordx4 v[72:75], v2, s[24:27], s44 offen offset:0 sc1
    s_add_u32 s51, s51, 1
    s_cmp_eq_u32 s51, 14
    s_cselect_b32 s51, 0, s51
    ds_read_b64_tr_b16 v[44:45], v6 offset:0
    ds_read_b64_tr_b16 v[46:47], v6 offset:1024
    ds_read_b64_tr_b16 v[40:41], v5 offset:0
    ds_read_b64_tr_b16 v[42:43], v5 offset:1024
    s_waitcnt vmcnt(4) lgkmcnt(0)
    v_mfma_f32_32x32x16_bf16 v[24:39], v[44:47], v[56:59], 0
    ds_read_b64_tr_b16 v[52:53], v6 offset:2048
    ds_read_b64_tr_b16 v[54:55], v6 offset:3072
    ds_read_b64_tr_b16 v[48:49], v5 offset:2048
    ds_read_b64_tr_b16 v[50:51], v5 offset:3072
    s_lshl_b32 s44, s51, 11
    v_mfma_f32_32x32x16_bf16 v[8:23], v[40:43], v[56:59], 0
    s_add_u32 s44, s44, s56
    buffer_load_dwordx4 v[76:79], v2, s[24:27], s44 offen offset:0 sc1
    s_add_u32 s51, s51, 1
    s_cmp_eq_u32 s51, 14
    s_cselect_b32 s51, 0, s51
    s_waitcnt vmcnt(4) lgkmcnt(0)
    v_mfma_f32_32x32x16_bf16 v[24:39], v[52:55], v[60:63], v[24:39]
    ds_read_b64_tr_b16 v[44:45], v6 offset:4096
    ds_read_b64_tr_b16 v[46:47], v6 offset:5120
    ds_read_b64_tr_b16 v[40:41], v5 offset:4096
    ds_read_b64_tr_b16 v[42:43], v5 offset:5120
    s_lshl_b32 s44, s51, 11
    v_mfma_f32_32x32x16_bf16 v[8:23], v[48:51], v[60:63], v[8:23]
    s_add_u32 s44, s44, s56
    buffer_load_dwordx4 v[80:83], v2, s[24:27], s44 offen offset:0 sc1
    s_add_u32 s51, s51, 1
    s_cmp_eq_u32 s51, 14
    s_cselect_b32 s51, 0, s51
    s_waitcnt vmcnt(4) lgkmcnt(0)
    v_mfma_f32_32x32x16_bf16 v[24:39], v[44:47], v[64:67], v[24:39]
    ds_read_b64_tr_b16 v[52:53], v6 offset:6144
    ds_read_b64_tr_b16 v[54:55], v6 offset:7168
    ds_read_b64_tr_b16 v[48:49], v5 offset:6144
    ds_read_b64_tr_b16 v[50:51], v5 offset:7168
    s_lshl_b32 s44, s51, 11
    v_mfma_f32_32x32x16_bf16 v[8:23], v[40:43], v[64:67], v[8:23]
    s_add_u32 s44, s44, s56
    buffer_load_dwordx4 v[84:87], v2, s[24:27], s44 offen offset:0 sc1
    s_add_u32 s51, s51, 1
    s_cmp_eq_u32 s51, 14
    s_cselect_b32 s51, 0, s51
    s_waitcnt vmcnt(4) lgkmcnt(0)
    v_mfma_f32_32x32x16_bf16 v[24:39], v[52:55], v[68:71], v[24:39]
    ds_read_b64_tr_b16 v[44:45], v6 offset:8192
    ds_read_b64_tr_b16 v[46:47], v6 offset:9216
    ds_read_b64_tr_b16 v[40:41], v5 offset:8192
    ds_read_b64_tr_b16 v[42:43], v5 offset:9216
    s_lshl_b32 s44, s51, 11
    v_mfma_f32_32x32x16_bf16 v[8:23], v[48:51], v[68:71], v[8:23]
    s_add_u32 s44, s44, s56
    buffer_load_dwordx4 v[56:59], v2, s[24:27], s44 offen offset:0 sc1
    s_add_u32 s51, s51, 1
    s_cmp_eq_u32 s51, 14
    s_cselect_b32 s51, 0, s51
    s_waitcnt vmcnt(4) lgkmcnt(0)
    v_mfma_f32_32x32x16_bf16 v[24:39], v[44:47], v[72:75], v[24:39]
    ds_read_b64_tr_b16 v[52:53], v6 offset:10240
    ds_read_b64_tr_b16 v[54:55], v6 offset:11264
    ds_read_b64_tr_b16 v[48:49], v5 offset:10240
    ds_read_b64_tr_b16 v[50:51], v5 offset:11264
    s_lshl_b32 s44, s51, 11
    v_mfma_f32_32x32x16_bf16 v[8:23], v[40:43], v[72:75], v[8:23]
    s_add_u32 s44, s44, s56
    buffer_load_dwordx4 v[60:63], v2, s[24:27], s44 offen offset:0 sc1
    s_add_u32 s51, s51, 1
    s_cmp_eq_u32 s51, 14
    s_cselect_b32 s51, 0, s51
    s_barrier
    s_waitcnt vmcnt(4) lgkmcnt(0)
    v_mfma_f32_32x32x16_bf16 v[24:39], v[52:55], v[76:79], v[24:39]
    ds_read_b64_tr_b16 v[44:45], v6 offset:12288
    ds_read_b64_tr_b16 v[46:47], v6 offset:13312
    ds_read_b64_tr_b16 v[40:41], v5 offset:12288
    ds_read_b64_tr_b16 v[42:43], v5 offset:13312
    s_lshl_b32 s44, s51, 11
    v_mfma_f32_32x32x16_bf16 v[8:23], v[48:51], v[76:79], v[8:23]
    s_add_u32 s44, s44, s56
    buffer_load_dwordx4 v[64:67], v2, s[24:27], s44 offen offset:0 sc1
    s_add_u32 s51, s51, 1
    s_cmp_eq_u32 s51, 14
    s_cselect_b32 s51, 0, s51
    s_waitcnt vmcnt(4) lgkmcnt(0)
    v_mfma_f32_32x32x16_bf16 v[24:39], v[44:47], v[80:83], v[24:39]
    ds_read_b64_tr_b16 v[52:53], v6 offset:14336
    ds_read_b64_tr_b16 v[54:55], v6 offset:15360
    ds_read_b64_tr_b16 v[48:49], v5 offset:14336
    ds_read_b64_tr_b16 v[50:51], v5 offset:15360
    s_lshl_b32 s44, s51, 11
    v_mfma_f32_32x32x16_bf16 v[8:23], v[40:43], v[80:83], v[8:23]
    s_add_u32 s44, s44, s56
    buffer_load_dwordx4 v[68:71], v2, s[24:27], s44 offen offset:0 sc1
    s_add_u32 s51, s51, 1
    s_cmp_eq_u32 s51, 14
    s_cselect_b32 s51, 0, s51
    s_waitcnt vmcnt(4) lgkmcnt(0)
    v_mfma_f32_32x32x16_bf16 v[24:39], v[52:55], v[84:87], v[24:39]
    ds_read_b64_tr_b16 v[44:45], v6 offset:16384
    ds_read_b64_tr_b16 v[46:47], v6 offset:17408
    ds_read_b64_tr_b16 v[40:41], v5 offset:16384
    ds_read_b64_tr_b16 v[42:43], v5 offset:17408
    s_lshl_b32 s44, s51, 11
    v_mfma_f32_32x32x16_bf16 v[8:23], v[48:51], v[84:87], v[8:23]
    s_add_u32 s44, s44, s56
    buffer_load_dwordx4 v[72:75], v2, s[24:27], s44 offen offset:0 sc1
    s_add_u32 s51, s51, 1
    s_cmp_eq_u32 s51, 14
    s_cselect_b32 s51, 0, s51
    s_waitcnt vmcnt(4) lgkmcnt(0)
    v_mfma_f32_32x32x16_bf16 v[24:39], v[44:47], v[56:59], v[24:39]
    ds_read_b64_tr_b16 v[52:53], v6 offset:18432
    ds_read_b64_tr_b16 v[54:55], v6 offset:19456
    ds_read_b64_tr_b16 v[48:49], v5 offset:18432
    ds_read_b64_tr_b16 v[50:51], v5 offset:19456
    s_lshl_b32 s44, s51, 11
    v_mfma_f32_32x32x16_bf16 v[8:23], v[40:43], v[56:59], v[8:23]
    s_add_u32 s44, s44, s56
    buffer_load_dwordx4 v[76:79], v2, s[24:27], s44 offen offset:0 sc1
    s_add_u32 s51, s51, 1
    s_cmp_eq_u32 s51, 14
    s_cselect_b32 s51, 0, s51
    s_barrier
    s_waitcnt vmcnt(4) lgkmcnt(0)
    v_mfma_f32_32x32x16_bf16 v[24:39], v[52:55], v[60:63], v[24:39]
    ds_read_b64_tr_b16 v[44:45], v6 offset:20480
    ds_read_b64_tr_b16 v[46:47], v6 offset:21504
    ds_read_b64_tr_b16 v[40:41], v5 offset:20480
    ds_read_b64_tr_b16 v[42:43], v5 offset:21504
    s_lshl_b32 s44, s51, 11
    v_mfma_f32_32x32x16_bf16 v[8:23], v[48:51], v[60:63], v[8:23]
    s_add_u32 s44, s44, s56
    buffer_load_dwordx4 v[80:83], v2, s[24:27], s44 offen offset:1024 sc1
    s_add_u32 s51, s51, 1
    s_cmp_eq_u32 s51, 14
    s_cselect_b32 s51, 0, s51
    s_waitcnt vmcnt(4) lgkmcnt(0)
    v_mfma_f32_32x32x16_bf16 v[24:39], v[44:47], v[64:67], v[24:39]
    ds_read_b64_tr_b16 v[52:53], v6 offset:22528
    ds_read_b64_tr_b16 v[54:55], v6 offset:23552
    ds_read_b64_tr_b16 v[48:49], v5 offset:22528
    ds_read_b64_tr_b16 v[50:51], v5 offset:23552
    s_lshl_b32 s44, s51, 11
    v_mfma_f32_32x32x16_bf16 v[8:23], v[40:43], v[64:67], v[8:23]
    s_add_u32 s44, s44, s56
    buffer_load_dwordx4 v[84:87], v2, s[24:27], s44 offen offset:1024 sc1
    s_add_u32 s51, s51, 1
    s_cmp_eq_u32 s51, 14
    s_cselect_b32 s51, 0, s51
    s_waitcnt vmcnt(4) lgkmcnt(0)
    v_mfma_f32_32x32x16_bf16 v[24:39], v[52:55], v[68:71], v[24:39]
    ds_read_b64_tr_b16 v[44:45], v6 offset:24576
    ds_read_b64_tr_b16 v[46:47], v6 offset:25600
    ds_read_b64_tr_b16 v[40:41], v5 offset:24576
    ds_read_b64_tr_b16 v[42:43], v5 offset:25600
    s_lshl_b32 s44, s51, 11
    v_mfma_f32_32x32x16_bf16 v[8:23], v[48:51], v[68:71], v[8:23]
    s_add_u32 s44, s44, s56
    buffer_load_dwordx4 v[56:59], v2, s[24:27], s44 offen offset:1024 sc1
    s_add_u32 s51, s51, 1
    s_cmp_eq_u32 s51, 14
    s_cselect_b32 s51, 0, s51
    s_waitcnt vmcnt(4) lgkmcnt(0)
    v_mfma_f32_32x32x16_bf16 v[24:39], v[44:47], v[72:75], v[24:39]
    ds_read_b64_tr_b16 v[52:53], v6 offset:26624
    ds_read_b64_tr_b16 v[54:55], v6 offset:27648
    ds_read_b64_tr_b16 v[48:49], v5 offset:26624
    ds_read_b64_tr_b16 v[50:51], v5 offset:27648
    s_lshl_b32 s44, s51, 11
    v_mfma_f32_32x32x16_bf16 v[8:23], v[40:43], v[72:75], v[8:23]
    s_add_u32 s44, s44, s56
    buffer_load_dwordx4 v[60:63], v2, s[24:27], s44 offen offset:1024 sc1
    s_add_u32 s51, s51, 1
    s_cmp_eq_u32 s51, 14
    s_cselect_b32 s51, 0, s51
    s_waitcnt vmcnt(4) lgkmcnt(0)
    v_mfma_f32_32x32x16_bf16 v[24:39], v[52:55], v[76:79], v[24:39]
    ds_read_b64_tr_b16 v[44:45], v6 offset:28672
    ds_read_b64_tr_b16 v[46:47], v6 offset:29696
    ds_read_b64_tr_b16 v[40:41], v5 offset:28672
    ds_read_b64_tr_b16 v[42:43], v5 offset:29696
    s_lshl_b32 s44, s51, 11
    v_mfma_f32_32x32x16_bf16 v[8:23], v[48:51], v[76:79], v[8:23]
    s_add_u32 s44, s44, s56
    buffer_load_dwordx4 v[64:67], v2, s[24:27], s44 offen offset:1024 sc1
    s_add_u32 s51, s51, 1
    s_cmp_eq_u32 s51, 14
    s_cselect_b32 s51, 0, s51
    s_waitcnt vmcnt(4) lgkmcnt(0)
    v_mfma_f32_32x32x16_bf16 v[24:39], v[44:47], v[80:83], v[24:39]
    ds_read_b64_tr_b16 v[52:53], v6 offset:30720
    ds_read_b64_tr_b16 v[54:55], v6 offset:31744
    ds_read_b64_tr_b16 v[48:49], v5 offset:30720
    ds_read_b64_tr_b16 v[50:51], v5 offset:31744
    s_lshl_b32 s44, s51, 11
    v_mfma_f32_32x32x16_bf16 v[8:23], v[40:43], v[80:83], v[8:23]
    s_add_u32 s44, s44, s56
    buffer_load_dwordx4 v[68:71], v2, s[24:27], s44 offen offset:1024 sc1
    s_add_u32 s51, s51, 1
    s_cmp_eq_u32 s51, 14
    s_cselect_b32 s51, 0, s51
    s_waitcnt vmcnt(4) lgkmcnt(0)
    v_mfma_f32_32x32x16_bf16 v[24:39], v[52:55], v[84:87], v[24:39]
    ds_read_b64_tr_b16 v[44:45], v6 offset:32768
    ds_read_b64_tr_b16 v[46:47], v6 offset:33792
    ds_read_b64_tr_b16 v[40:41], v5 offset:32768
    ds_read_b64_tr_b16 v[42:43], v5 offset:33792
    s_lshl_b32 s44, s51, 11
    v_mfma_f32_32x32x16_bf16 v[8:23], v[48:51], v[84:87], v[8:23]
    s_add_u32 s44, s44, s56
    buffer_load_dwordx4 v[72:75], v2, s[24:27], s44 offen offset:1024 sc1
    s_add_u32 s51, s51, 1
    s_cmp_eq_u32 s51, 14
    s_cselect_b32 s51, 0, s51
    s_waitcnt vmcnt(4) lgkmcnt(0)
    v_mfma_f32_32x32x16_bf16 v[24:39], v[44:47], v[56:59], v[24:39]
    ds_read_b64_tr_b16 v[52:53], v6 offset:34816
    ds_read_b64_tr_b16 v[54:55], v6 offset:35840
    ds_read_b64_tr_b16 v[48:49], v5 offset:34816
    ds_read_b64_tr_b16 v[50:51], v5 offset:35840
    s_lshl_b32 s44, s51, 11
    v_mfma_f32_32x32x16_bf16 v[8:23], v[40:43], v[56:59], v[8:23]
    s_add_u32 s44, s44, s56
    buffer_load_dwordx4 v[76:79], v2, s[24:27], s44 offen offset:1024 sc1
    s_add_u32 s51, s51, 1
    s_cmp_eq_u32 s51, 14
    s_cselect_b32 s51, 0, s51
    s_waitcnt vmcnt(4) lgkmcnt(0)
    v_mfma_f32_32x32x16_bf16 v[24:39], v[52:55], v[60:63], v[24:39]
    ds_read_b64_tr_b16 v[44:45], v6 offset:36864
    ds_read_b64_tr_b16 v[46:47], v6 offset:37888
    ds_read_b64_tr_b16 v[40:41], v5 offset:36864
    ds_read_b64_tr_b16 v[42:43], v5 offset:37888
    s_lshl_b32 s44, s51, 11
    v_mfma_f32_32x32x16_bf16 v[8:23], v[48:51], v[60:63], v[8:23]
    s_add_u32 s44, s44, s56
    buffer_load_dwordx4 v[80:83], v2, s[24:27], s44 offen offset:1024 sc1
    s_add_u32 s51, s51, 1
    s_cmp_eq_u32 s51, 14
    s_cselect_b32 s51, 0, s51
    s_barrier
    s_waitcnt vmcnt(4) lgkmcnt(0)
    v_mfma_f32_32x32x16_bf16 v[24:39], v[44:47], v[64:67], v[24:39]
    ds_read_b64_tr_b16 v[52:53], v6 offset:0
    ds_read_b64_tr_b16 v[54:55], v6 offset:1024
    ds_read_b64_tr_b16 v[48:49], v5 offset:0
    ds_read_b64_tr_b16 v[50:51], v5 offset:1024
    s_lshl_b32 s44, s51, 11
    v_mfma_f32_32x32x16_bf16 v[8:23], v[40:43], v[64:67], v[8:23]
    s_add_u32 s44, s44, s56
    buffer_load_dwordx4 v[84:87], v2, s[24:27], s44 offen offset:1024 sc1
    s_add_u32 s51, s51, 1
    s_cmp_eq_u32 s51, 14
    s_cselect_b32 s51, 0, s51
    s_waitcnt vmcnt(4) lgkmcnt(0)
    v_mfma_f32_32x32x16_bf16 v[24:39], v[52:55], v[68:71], v[24:39]
    ds_read_b64_tr_b16 v[44:45], v6 offset:2048
    ds_read_b64_tr_b16 v[46:47], v6 offset:3072
    ds_read_b64_tr_b16 v[40:41], v5 offset:2048
    ds_read_b64_tr_b16 v[42:43], v5 offset:3072
    s_lshl_b32 s44, s51, 11
    v_mfma_f32_32x32x16_bf16 v[8:23], v[48:51], v[68:71], v[8:23]
    s_add_u32 s44, s44, s56
    buffer_load_dwordx4 v[56:59], v2, s[24:27], s44 offen offset:1024 sc1
    s_add_u32 s51, s51, 1
    s_cmp_eq_u32 s51, 14
    s_cselect_b32 s51, 0, s51
    s_waitcnt vmcnt(4) lgkmcnt(0)
    v_mfma_f32_32x32x16_bf16 v[24:39], v[44:47], v[72:75], v[24:39]
    ds_read_b64_tr_b16 v[52:53], v6 offset:4096
    ds_read_b64_tr_b16 v[54:55], v6 offset:5120
    ds_read_b64_tr_b16 v[48:49], v5 offset:4096
    ds_read_b64_tr_b16 v[50:51], v5 offset:5120
    s_lshl_b32 s44, s51, 11
    v_mfma_f32_32x32x16_bf16 v[8:23], v[40:43], v[72:75], v[8:23]
    s_add_u32 s44, s44, s56
    buffer_load_dwordx4 v[60:63], v2, s[24:27], s44 offen offset:1024 sc1
    s_add_u32 s51, s51, 1
    s_cmp_eq_u32 s51, 14
    s_cselect_b32 s51, 0, s51
    s_waitcnt vmcnt(4) lgkmcnt(0)
    v_mfma_f32_32x32x16_bf16 v[24:39], v[52:55], v[76:79], v[24:39]
    ds_read_b64_tr_b16 v[44:45], v6 offset:6144
    ds_read_b64_tr_b16 v[46:47], v6 offset:7168
    ds_read_b64_tr_b16 v[40:41], v5 offset:6144
    ds_read_b64_tr_b16 v[42:43], v5 offset:7168
    s_lshl_b32 s44, s51, 11
    v_mfma_f32_32x32x16_bf16 v[8:23], v[48:51], v[76:79], v[8:23]
    s_add_u32 s44, s44, s56
    buffer_load_dwordx4 v[64:67], v2, s[24:27], s44 offen offset:1024 sc1
    s_add_u32 s51, s51, 1
    s_cmp_eq_u32 s51, 14
    s_cselect_b32 s51, 0, s51
    s_waitcnt vmcnt(4) lgkmcnt(0)
    v_mfma_f32_32x32x16_bf16 v[24:39], v[44:47], v[80:83], v[24:39]
    ds_read_b64_tr_b16 v[52:53], v6 offset:8192
    ds_read_b64_tr_b16 v[54:55], v6 offset:9216
    ds_read_b64_tr_b16 v[48:49], v5 offset:8192
    ds_read_b64_tr_b16 v[50:51], v5 offset:9216
    s_lshl_b32 s44, s51, 11
    v_mfma_f32_32x32x16_bf16 v[8:23], v[40:43], v[80:83], v[8:23]
    s_add_u32 s44, s44, s56
    buffer_load_dwordx4 v[68:71], v2, s[24:27], s44 offen offset:1024 sc1
    s_add_u32 s51, s51, 1
    s_cmp_eq_u32 s51, 14
    s_cselect_b32 s51, 0, s51
    s_waitcnt vmcnt(4) lgkmcnt(0)
    v_mfma_f32_32x32x16_bf16 v[24:39], v[52:55], v[84:87], v[24:39]
    ds_read_b64_tr_b16 v[44:45], v6 offset:10240
    ds_read_b64_tr_b16 v[46:47], v6 offset:11264
    v_mfma_f32_32x32x16_bf16 v[8:23], v[48:51], v[84:87], v[8:23]
    ds_read_b64_tr_b16 v[40:41], v5 offset:10240
    ds_read_b64_tr_b16 v[42:43], v5 offset:11264
    s_waitcnt vmcnt(3) lgkmcnt(0)
    v_mfma_f32_32x32x16_bf16 v[24:39], v[44:47], v[56:59], v[24:39]
    ds_read_b64_tr_b16 v[52:53], v6 offset:12288
    ds_read_b64_tr_b16 v[54:55], v6 offset:13312
    v_mfma_f32_32x32x16_bf16 v[8:23], v[40:43], v[56:59], v[8:23]
    ds_read_b64_tr_b16 v[48:49], v5 offset:12288
    ds_read_b64_tr_b16 v[50:51], v5 offset:13312
    s_waitcnt vmcnt(2) lgkmcnt(0)
    v_mfma_f32_32x32x16_bf16 v[24:39], v[52:55], v[60:63], v[24:39]
    ds_read_b64_tr_b16 v[44:45], v6 offset:14336
    ds_read_b64_tr_b16 v[46:47], v6 offset:15360
    v_mfma_f32_32x32x16_bf16 v[8:23], v[48:51], v[60:63], v[8:23]
    ds_read_b64_tr_b16 v[40:41], v5 offset:14336
    ds_read_b64_tr_b16 v[42:43], v5 offset:15360
    s_waitcnt vmcnt(1) lgkmcnt(0)
    v_mfma_f32_32x32x16_bf16 v[24:39], v[44:47], v[64:67], v[24:39]
    ds_read_b64_tr_b16 v[52:53], v6 offset:16384
    ds_read_b64_tr_b16 v[54:55], v6 offset:17408
    v_mfma_f32_32x32x16_bf16 v[8:23], v[40:43], v[64:67], v[8:23]
    ds_read_b64_tr_b16 v[48:49], v5 offset:16384
    ds_read_b64_tr_b16 v[50:51], v5 offset:17408
    s_waitcnt vmcnt(0) lgkmcnt(0)
    v_mfma_f32_32x32x16_bf16 v[24:39], v[52:55], v[68:71], v[24:39]
    v_mfma_f32_32x32x16_bf16 v[8:23], v[48:51], v[68:71], v[8:23]
    s_nop 7
    s_nop 3
    ds_write_b128 v1, v[32:35] offset:6144
    ds_write_b128 v1, v[36:39] offset:7168
    ds_write_b128 v1, v[24:27] offset:4096
    ds_write_b128 v1, v[28:31] offset:5120
    ds_write_b128 v1, v[16:19] offset:2048
    ds_write_b128 v1, v[20:23] offset:3072
    v_lshlrev_b32 v40, 16, v120
    v_and_b32 v41, s50, v120
    v_lshlrev_b32 v42, 16, v121
    v_and_b32 v43, s50, v121
    v_lshlrev_b32 v44, 16, v122
    v_and_b32 v45, s50, v122
    v_lshlrev_b32 v46, 16, v123
    v_and_b32 v47, s50, v123
    v_add_f32 v8, v8, v40
    v_add_f32 v9, v9, v41
    v_add_f32 v10, v10, v42
    v_add_f32 v11, v11, v43
    v_add_f32 v12, v12, v44
    v_add_f32 v13, v13, v45
    v_add_f32 v14, v14, v46
    v_add_f32 v15, v15, v47
    s_waitcnt lgkmcnt(0)
    s_barrier
    ds_read_b128 v[88:91], v117 offset:2048
    ds_read_b128 v[92:95], v117 offset:3072
    ds_read_b128 v[96:99], v118 offset:4096
    ds_read_b128 v[100:103], v118 offset:5120
    ds_read_b128 v[104:107], v119 offset:6144
    ds_read_b128 v[108:111], v119 offset:7168
    s_waitcnt lgkmcnt(2)
    v_add_f32 v88, v88, v96
    v_add_f32 v89, v89, v97
    v_add_f32 v90, v90, v98
    v_add_f32 v91, v91, v99
    v_add_f32 v92, v92, v100
    v_add_f32 v93, v93, v101
    v_add_f32 v94, v94, v102
    v_add_f32 v95, v95, v103
    s_waitcnt lgkmcnt(0)
    v_add_f32 v8, v8, v104
    v_add_f32 v9, v9, v105
    v_add_f32 v10, v10, v106
    v_add_f32 v11, v11, v107
    v_add_f32 v12, v12, v108
    v_add_f32 v13, v13, v109
    v_add_f32 v14, v14, v110
    v_add_f32 v15, v15, v111
    v_add_f32 v8, v8, v88
    v_add_f32 v9, v9, v89
    v_add_f32 v10, v10, v90
    v_add_f32 v11, v11, v91
    v_add_f32 v12, v12, v92
    v_add_f32 v13, v13, v93
    v_add_f32 v14, v14, v94
    v_add_f32 v15, v15, v95
    v_cvt_pk_bf16_f32 v24, v8, v9
    v_cvt_pk_bf16_f32 v25, v10, v11
    v_cvt_pk_bf16_f32 v26, v12, v13
    v_cvt_pk_bf16_f32 v27, v14, v15
    s_nop 1
    v_permlane32_swap_b32 v24, v26
    v_permlane32_swap_b32 v25, v27
    s_nop 1
    buffer_store_dwordx4 v[24:27], v7, s[32:35], s61 offen
    s_branch k2_main_kernel_end
k2_main_kernel_ldr:
    s_setprio 3
    s_sub_u32 s49, s36, 8
    v_lshrrev_b32 v1, 3, v0
    v_and_b32 v5, 7, v0
    v_lshlrev_b32 v6, 1, v1
    v_and_b32 v6, 4, v6
    v_xor_b32 v6, v6, v5
    v_lshlrev_b32 v6, 4, v6
    v_lshl_add_u32 v15, v1, 10, v6
    s_add_u32 s46, s59, 2105344
    s_add_u32 s47, s59, 4202496
    s_mov_b32 s48, 8192
    v_mov_b32 v16, 143360
    s_mov_b32 s55, 1
    s_waitcnt lgkmcnt(0)
    s_mov_b32 s24, s20
    s_mov_b32 s25, s21
    s_mov_b32 s26, 19070976
    s_mov_b32 s27, 0x00020000
    s_barrier
    s_cmp_lg_u32 s49, 0
    s_cbranch_scc1 k2_main_kernel_ldr3
k2_main_kernel_kvl:
    s_add_u32 m0, s48, 0
    s_add_u32 s44, s46, 0
    buffer_load_dwordx4 v2, s[24:27], s44 offen offset:0  lds
    buffer_load_dwordx4 v2, s[24:27], s44 offen offset:1024  lds
    buffer_load_dwordx4 v2, s[24:27], s44 offen offset:2048  lds
    buffer_load_dwordx4 v2, s[24:27], s44 offen offset:3072  lds
    s_add_u32 m0, s48, 65536
    s_add_u32 s44, s47, 0
    buffer_load_dwordx4 v2, s[24:27], s44 offen offset:0  lds
    buffer_load_dwordx4 v2, s[24:27], s44 offen offset:1024  lds
    buffer_load_dwordx4 v2, s[24:27], s44 offen offset:2048  lds
    buffer_load_dwordx4 v2, s[24:27], s44 offen offset:3072  lds
    s_add_u32 m0, s48, 4096
    s_add_u32 s44, s46, 4096
    buffer_load_dwordx4 v2, s[24:27], s44 offen offset:0  lds
    buffer_load_dwordx4 v2, s[24:27], s44 offen offset:1024  lds
    buffer_load_dwordx4 v2, s[24:27], s44 offen offset:2048  lds
    buffer_load_dwordx4 v2, s[24:27], s44 offen offset:3072  lds
    s_add_u32 m0, s48, 69632
    s_add_u32 s44, s47, 4096
    buffer_load_dwordx4 v2, s[24:27], s44 offen offset:0  lds
    buffer_load_dwordx4 v2, s[24:27], s44 offen offset:1024  lds
    buffer_load_dwordx4 v2, s[24:27], s44 offen offset:2048  lds
    buffer_load_dwordx4 v2, s[24:27], s44 offen offset:3072  lds
    s_add_u32 s46, s46, 8192
    s_add_u32 s47, s47, 8192
    s_add_u32 s48, s48, 8192
    v_mov_b32 v17, s55
    s_add_u32 s55, s55, 1
    s_waitcnt vmcnt(16)
    ds_write_b32 v16, v17
    s_cmp_lt_u32 s55, 8
    s_cbranch_scc1 k2_main_kernel_kvl
    v_mov_b32 v17, 8
    s_waitcnt vmcnt(0)
    ds_write_b32 v16, v17
    s_mov_b32 s28, s12
    s_mov_b32 s29, s13
    s_mov_b32 s30, 1835008
    s_mov_b32 s31, 0x00020000
    s_cmp_ge_u32 s2, 224
    s_cbranch_scc1 k2_main_kernel_nocs
    v_mul_u32_u24 v8, 3584, v1
    v_add_u32 v8, v8, v6
    s_mul_i32 s46, s37, 229376
    s_lshl_b32 s47, s38, 7
    s_add_u32 s46, s46, s47
    s_mov_b32 m0, 143616
    s_add_u32 s47, s46, 0
    buffer_load_dwordx4 v8, s[28:31], s47 offen lds
    s_mov_b32 m0, 144640
    s_add_u32 s47, s46, 28672
    buffer_load_dwordx4 v8, s[28:31], s47 offen lds
    s_mov_b32 m0, 145664
    s_add_u32 s47, s46, 57344
    buffer_load_dwordx4 v8, s[28:31], s47 offen lds
    s_mov_b32 m0, 146688
    s_add_u32 s47, s46, 86016
    buffer_load_dwordx4 v8, s[28:31], s47 offen lds
    s_mov_b32 m0, 147712
    s_add_u32 s47, s46, 114688
    buffer_load_dwordx4 v8, s[28:31], s47 offen lds
    s_mov_b32 m0, 148736
    s_add_u32 s47, s46, 143360
    buffer_load_dwordx4 v8, s[28:31], s47 offen lds
    s_mov_b32 m0, 149760
    s_add_u32 s47, s46, 172032
    buffer_load_dwordx4 v8, s[28:31], s47 offen lds
    s_mov_b32 m0, 150784
    s_add_u32 s47, s46, 200704
    buffer_load_dwordx4 v8, s[28:31], s47 offen lds
    v_bfe_u32 v10, v0, 2, 2
    v_lshl_add_u32 v11, v124, 2, v10
    v_lshlrev_b32 v12, 7, v11
    v_lshrrev_b32 v10, 1, v10
    v_lshl_add_u32 v12, v10, 6, v12
    v_bfe_u32 v10, v0, 4, 1
    v_lshl_add_u32 v12, v10, 5, v12
    v_and_b32 v10, 3, v0
    v_lshl_add_u32 v12, v10, 3, v12
    v_add_u32 v12, 143616, v12
    v_xor_b32 v13, 64, v12
    v_mov_b32 v20, 0x3f803f80
    v_mov_b32 v21, 0x3f803f80
    v_mov_b32 v22, 0x3f803f80
    v_mov_b32 v23, 0x3f803f80
    v_lshlrev_b32 v14, 2, v0
    v_cmp_eq_u32 vcc, 0, v124
    s_waitcnt vmcnt(0)
    ds_read_b64_tr_b16 v[72:73], v12 offset:0
    ds_read_b64_tr_b16 v[74:75], v12 offset:1024
    ds_read_b64_tr_b16 v[76:77], v13 offset:0
    ds_read_b64_tr_b16 v[78:79], v13 offset:1024
    s_waitcnt lgkmcnt(0)
    v_mfma_f32_32x32x16_bf16 v[40:55], v[20:23], v[72:75], 0
    v_mfma_f32_32x32x16_bf16 v[56:71], v[20:23], v[76:79], 0
    ds_read_b64_tr_b16 v[72:73], v12 offset:2048
    ds_read_b64_tr_b16 v[74:75], v12 offset:3072
    ds_read_b64_tr_b16 v[76:77], v13 offset:2048
    ds_read_b64_tr_b16 v[78:79], v13 offset:3072
    s_waitcnt lgkmcnt(0)
    v_mfma_f32_32x32x16_bf16 v[40:55], v[20:23], v[72:75], v[40:55]
    v_mfma_f32_32x32x16_bf16 v[56:71], v[20:23], v[76:79], v[56:71]
    ds_read_b64_tr_b16 v[72:73], v12 offset:4096
    ds_read_b64_tr_b16 v[74:75], v12 offset:5120
    ds_read_b64_tr_b16 v[76:77], v13 offset:4096
    ds_read_b64_tr_b16 v[78:79], v13 offset:5120
    s_waitcnt lgkmcnt(0)
    v_mfma_f32_32x32x16_bf16 v[40:55], v[20:23], v[72:75], v[40:55]
    v_mfma_f32_32x32x16_bf16 v[56:71], v[20:23], v[76:79], v[56:71]
    ds_read_b64_tr_b16 v[72:73], v12 offset:6144
    ds_read_b64_tr_b16 v[74:75], v12 offset:7168
    ds_read_b64_tr_b16 v[76:77], v13 offset:6144
    ds_read_b64_tr_b16 v[78:79], v13 offset:7168
    s_waitcnt lgkmcnt(0)
    v_mfma_f32_32x32x16_bf16 v[40:55], v[20:23], v[72:75], v[40:55]
    v_mfma_f32_32x32x16_bf16 v[56:71], v[20:23], v[76:79], v[56:71]
    s_mul_i32 s46, s37, 7168
    s_lshl_b32 s47, s38, 8
    s_add_u32 s46, s46, s47
    s_add_u32 s46, s46, 11010048
    s_nop 7
    s_nop 3
    v_cndmask_b32 v9, v56, v40, vcc
    buffer_store_dword v9, v14, s[24:27], s46 offen sc1
k2_main_kernel_nocs:
    v_mov_b32 v3, 155656
    v_mov_b32 v4, 1
    s_lshl_b32 s44, s2, 7
    s_add_u32 s44, s44, 19005440
    s_mov_b64 exec, 1
    s_waitcnt vmcnt(0)
    ds_add_rtn_u32 v7, v3, v4
    v_mov_b32 v3, 0
    s_waitcnt lgkmcnt(0)
    v_mov_b32 v4, 1
    v_readfirstlane_b32 s45, v7
    s_nop 0
    s_cmp_eq_u32 s45, 8
    s_cbranch_scc0 k2_main_kernel_ns2l
    buffer_store_dword v4, v3, s[24:27], s44 offen sc1
k2_main_kernel_ns2l:
    s_mov_b64 exec, -1
    s_mov_b32 s32, s16
    s_mov_b32 s33, s17
    s_mov_b32 s34, 1835008
    s_mov_b32 s35, 0x00020000
    v_lshlrev_b32 v3, 7, v0
    s_mul_i32 s46, s2, 7168
    buffer_load_dword v24, v3, s[32:35], s46 offen
    s_mul_i32 s46, s38, 57344
    s_add_u32 s47, s46, 0
    buffer_load_dword v25, v3, s[28:31], s47 offen
    s_add_u32 s47, s46, 8192
    buffer_load_dword v26, v3, s[28:31], s47 offen
    s_add_u32 s47, s46, 16384
    buffer_load_dword v27, v3, s[28:31], s47 offen
    s_add_u32 s47, s46, 24576
    buffer_load_dword v28, v3, s[28:31], s47 offen
    s_add_u32 s47, s46, 32768
    buffer_load_dword v29, v3, s[28:31], s47 offen
    s_add_u32 s47, s46, 40960
    buffer_load_dword v30, v3, s[28:31], s47 offen
    s_add_u32 s47, s46, 49152
    buffer_load_dword v31, v3, s[28:31], s47 offen
    s_mov_b32 s28, s8
    s_mov_b32 s29, s9
    s_mov_b32 s30, 524288
    s_mov_b32 s31, 0x00020000
    s_mov_b32 s32, s4
    s_mov_b32 s33, s5
    s_mov_b32 s34, 2097152
    s_mov_b32 s35, 0x00020000
    s_lshl_b32 s46, s38, 14
    s_add_u32 s47, s46, 8192
    buffer_load_dword v32, v3, s[28:31], s46 offen
    buffer_load_dword v33, v3, s[28:31], s47 offen
    s_lshl_b32 s46, s37, 18
    s_lshl_b32 s47, s38, 13
    s_add_u32 s46, s46, s47
    buffer_load_dword v34, v3, s[32:35], s46 offen
    s_waitcnt vmcnt(0) lgkmcnt(0)
k2_main_kernel_ldr3:
    s_setprio 2
    s_lshl_b32 s58, s49, 17
    s_lshl_b32 s44, s40, 7
    s_add_u32 s58, s58, s44
    s_lshl_b32 s59, s49, 14
    s_add_u32 s59, s59, 81920
    s_mov_b32 s28, s8
    s_mov_b32 s29, s9
    s_mov_b32 s30, 524288
    s_mov_b32 s31, 0x00020000
    s_barrier
    s_add_u32 m0, s59, 0
    s_add_u32 s44, s58, 0
    buffer_load_dwordx4 v15, s[28:31], s44 offen offset:0 lds
    s_add_u32 s44, s58, 7168
    buffer_load_dwordx4 v15, s[28:31], s44 offen offset:1024 lds
    s_add_u32 s44, s58, 14336
    buffer_load_dwordx4 v15, s[28:31], s44 offen offset:2048 lds
    s_add_u32 s44, s58, 21504
    buffer_load_dwordx4 v15, s[28:31], s44 offen offset:3072 lds
    s_add_u32 m0, s59, 4096
    s_add_u32 s44, s58, 32768
    buffer_load_dwordx4 v15, s[28:31], s44 offen offset:0 lds
    s_add_u32 s44, s58, 39936
    buffer_load_dwordx4 v15, s[28:31], s44 offen offset:1024 lds
    s_add_u32 s44, s58, 47104
    buffer_load_dwordx4 v15, s[28:31], s44 offen offset:2048 lds
    s_add_u32 s44, s58, 54272
    buffer_load_dwordx4 v15, s[28:31], s44 offen offset:3072 lds
    s_add_u32 m0, s59, 8192
    s_add_u32 s44, s58, 65536
    buffer_load_dwordx4 v15, s[28:31], s44 offen offset:0 lds
    s_add_u32 s44, s58, 72704
    buffer_load_dwordx4 v15, s[28:31], s44 offen offset:1024 lds
    s_add_u32 s44, s58, 79872
    buffer_load_dwordx4 v15, s[28:31], s44 offen offset:2048 lds
    s_add_u32 s44, s58, 87040
    buffer_load_dwordx4 v15, s[28:31], s44 offen offset:3072 lds
    s_add_u32 m0, s59, 12288
    s_add_u32 s44, s58, 98304
    buffer_load_dwordx4 v15, s[28:31], s44 offen offset:0 lds
    s_add_u32 s44, s58, 105472
    buffer_load_dwordx4 v15, s[28:31], s44 offen offset:1024 lds
    s_add_u32 s44, s58, 112640
    buffer_load_dwordx4 v15, s[28:31], s44 offen offset:2048 lds
    s_add_u32 s44, s58, 119808
    buffer_load_dwordx4 v15, s[28:31], s44 offen offset:3072 lds
    s_mov_b32 s32, s4
    s_mov_b32 s33, s5
    s_mov_b32 s34, 2097152
    s_mov_b32 s35, 0x00020000
    v_lshrrev_b32 v8, 1, v1
    v_xor_b32 v8, v8, v5
    v_lshlrev_b32 v8, 4, v8
    v_lshl_add_u32 v8, v1, 10, v8
    v_xor_b32 v9, 64, v8
    s_lshl_b32 s60, s39, 16
    s_lshl_b32 s44, s49, 14
    s_add_u32 s60, s60, s44
    s_lshl_b32 s44, s40, 7
    s_add_u32 s60, s60, s44
    s_lshl_b32 s44, s49, 11
    s_add_u32 m0, s44, 147456
    s_add_u32 s45, s60, 7168
    buffer_load_dwordx4 v8, s[32:35], s60 offen lds
    buffer_load_dwordx4 v9, s[32:35], s45 offen offset:1024 lds
    s_lshl_b32 s44, s49, 3
    v_add_u32 v1, s44, v1
    v_mul_u32_u24 v4, 3584, v1
    v_add_u32 v4, v4, v6
    s_lshl_b32 s51, s49, 10
    s_lshl_b32 s52, s49, 11
    s_lshl_b32 s44, s41, 2
    s_add_u32 s53, s44, s49
    s_lshl_b32 s54, s53, 15
    s_add_u32 s54, s54, 8388608
    s_and_b32 s44, s38, 1
    s_lshl_b32 s44, s44, 3
    s_add_u32 s55, s44, s42
    s_and_b32 s55, s55, 15
    s_mov_b32 s56, s55
    s_lshl_b32 s57, s42, 8
    v_and_b32 v3, 31, v0
    v_mul_u32_u24 v10, 28672, v124
    v_lshl_add_u32 v10, v3, 2, v10
    v_lshlrev_b32 v11, 1, v3
    s_lshl_b32 s58, s42, 9
    s_lshl_b32 s44, s49, 7
    s_add_u32 s58, s58, s44
    s_add_u32 s58, s58, 11010048
    s_lshl_b32 s44, s49, 6
    s_add_u32 s59, s57, s44
    v_lshlrev_b32 v12, 3, v3
    v_lshl_add_u32 v12, v124, 12, v12
    s_lshl_b32 s60, s53, 13
    s_add_u32 s60, s60, 10485760
    v_add_u32 v13, s51, v2
    v_add_u32 v13, 147456, v13
    s_lshl_b32 s44, s49, 8
    v_lshlrev_b32 v14, 2, v0
    v_add_u32 v14, s44, v14
    v_add_u32 v14, 156672, v14
    v_cmp_eq_u32 vcc, 0, v124
    s_mov_b32 s28, s12
    s_mov_b32 s29, s13
    s_mov_b32 s30, 1835008
    s_mov_b32 s31, 0x00020000
    s_mov_b32 s32, s14
    s_mov_b32 s33, s15
    s_mov_b32 s34, 3584
    s_mov_b32 s35, 0x00020000
    s_cmp_ge_u32 s38, 28
    s_cbranch_scc0 k2_main_kernel_ldr4
    s_waitcnt vmcnt(0)
    s_barrier
    s_barrier
    s_barrier
    s_branch k2_main_kernel_ldr5
k2_main_kernel_ldr4:
    s_mul_i32 s44, s55, 114688
    s_add_u32 m0, s51, 0
    s_add_u32 s44, s44, s57
    buffer_load_dwordx4 v4, s[28:31], s44 offen lds
    s_add_u32 m0, s51, 4096
    s_add_u32 s44, s44, 128
    buffer_load_dwordx4 v4, s[28:31], s44 offen lds
    s_add_u32 s55, s55, 1
    s_and_b32 s55, s55, 15
    s_mul_i32 s44, s55, 114688
    s_add_u32 m0, s51, 8192
    s_add_u32 s44, s44, s57
    buffer_load_dwordx4 v4, s[28:31], s44 offen lds
    s_add_u32 m0, s51, 12288
    s_add_u32 s44, s44, 128
    buffer_load_dwordx4 v4, s[28:31], s44 offen lds
    s_add_u32 s55, s55, 1
    s_and_b32 s55, s55, 15
    s_waitcnt vmcnt(4)
    s_barrier
    s_barrier
    s_barrier
    s_mul_i32 s44, s55, 114688
    s_add_u32 m0, s51, 16384
    s_add_u32 s44, s44, s57
    buffer_load_dwordx4 v4, s[28:31], s44 offen lds
    s_add_u32 m0, s51, 20480
    s_add_u32 s44, s44, 128
    buffer_load_dwordx4 v4, s[28:31], s44 offen lds
    s_add_u32 s55, s55, 1
    s_and_b32 s55, s55, 15
    s_mul_i32 s44, s55, 114688
    s_add_u32 m0, s51, 24576
    s_add_u32 s44, s44, s57
    buffer_load_dwordx4 v4, s[28:31], s44 offen lds
    s_add_u32 m0, s51, 28672
    s_add_u32 s44, s44, 128
    buffer_load_dwordx4 v4, s[28:31], s44 offen lds
    s_add_u32 s55, s55, 1
    s_and_b32 s55, s55, 15
    s_mul_i32 s44, s55, 114688
    s_add_u32 m0, s51, 32768
    s_add_u32 s44, s44, s57
    buffer_load_dwordx4 v4, s[28:31], s44 offen lds
    s_add_u32 m0, s51, 36864
    s_add_u32 s44, s44, 128
    buffer_load_dwordx4 v4, s[28:31], s44 offen lds
    s_add_u32 s55, s55, 1
    s_and_b32 s55, s55, 15
    s_mul_i32 s44, s55, 114688
    s_add_u32 m0, s51, 40960
    s_add_u32 s44, s44, s57
    buffer_load_dwordx4 v4, s[28:31], s44 offen lds
    s_add_u32 m0, s51, 45056
    s_add_u32 s44, s44, 128
    buffer_load_dwordx4 v4, s[28:31], s44 offen lds
    s_add_u32 s55, s55, 1
    s_and_b32 s55, s55, 15
    s_mul_i32 s44, s55, 114688
    s_add_u32 m0, s51, 49152
    s_add_u32 s44, s44, s57
    buffer_load_dwordx4 v4, s[28:31], s44 offen lds
    s_add_u32 m0, s51, 53248
    s_add_u32 s44, s44, 128
    buffer_load_dwordx4 v4, s[28:31], s44 offen lds
    s_add_u32 s55, s55, 1
    s_and_b32 s55, s55, 15
    s_mul_i32 s44, s55, 114688
    s_add_u32 m0, s51, 57344
    s_add_u32 s44, s44, s57
    buffer_load_dwordx4 v4, s[28:31], s44 offen lds
    s_add_u32 m0, s51, 61440
    s_add_u32 s44, s44, 128
    buffer_load_dwordx4 v4, s[28:31], s44 offen lds
    s_add_u32 s55, s55, 1
    s_and_b32 s55, s55, 15
    s_mul_i32 s44, s55, 114688
    s_add_u32 m0, s51, 65536
    s_add_u32 s44, s44, s57
    buffer_load_dwordx4 v4, s[28:31], s44 offen lds
    s_add_u32 m0, s51, 69632
    s_add_u32 s44, s44, 128
    buffer_load_dwordx4 v4, s[28:31], s44 offen lds
    s_add_u32 s55, s55, 1
    s_and_b32 s55, s55, 15
    s_mul_i32 s44, s55, 114688
    s_add_u32 m0, s51, 73728
    s_add_u32 s44, s44, s57
    buffer_load_dwordx4 v4, s[28:31], s44 offen lds
    s_add_u32 m0, s51, 77824
    s_add_u32 s44, s44, 128
    buffer_load_dwordx4 v4, s[28:31], s44 offen lds
    s_add_u32 s55, s55, 1
    s_and_b32 s55, s55, 15
    s_mul_i32 s44, s55, 114688
    s_add_u32 m0, s51, 81920
    s_add_u32 s44, s44, s57
    buffer_load_dwordx4 v4, s[28:31], s44 offen lds
    s_add_u32 m0, s51, 86016
    s_add_u32 s44, s44, 128
    buffer_load_dwordx4 v4, s[28:31], s44 offen lds
    s_add_u32 s55, s55, 1
    s_and_b32 s55, s55, 15
    s_lshl_b32 s44, s42, 1
    s_lshr_b32 s45, s49, 1
    s_add_u32 s44, s44, s45
    s_lshl_b32 s44, s44, 3
    v_add_u32 v3, s44, v0
    v_lshlrev_b32 v3, 7, v3
    s_mov_b32 exec_lo, 0xff
    s_mov_b32 exec_hi, 0
    s_mov_b32 s45, 262144
    s_mov_b32 s44, 19005440
    s_mov_b32 s46, 19070976
    s_mov_b64 s[62:63], -1
k2_main_kernel_plc:
    buffer_load_dword v89, v3, s[24:27], s44 offen sc1
    s_sub_u32 s45, s45, 1
    s_waitcnt vmcnt(0)
    v_cmp_ne_u32 vcc, 1, v89
    s_cmp_eq_u32 s45, 0
    s_cbranch_scc1 k2_main_kernel_pdc
    s_nop 2
    s_and_b64 s[62:63], vcc, exec
    s_cbranch_scc1 k2_main_kernel_plc
k2_main_kernel_pdc:
    s_mov_b64 exec, -1
    s_add_u32 s44, s58, 0
    buffer_load_dword v60, v10, s[24:27], s44 offen sc1
    s_add_u32 s44, s58, 7168
    buffer_load_dword v61, v10, s[24:27], s44 offen sc1
    s_add_u32 s44, s58, 14336
    buffer_load_dword v62, v10, s[24:27], s44 offen sc1
    s_add_u32 s44, s58, 21504
    buffer_load_dword v63, v10, s[24:27], s44 offen sc1
    buffer_load_ushort v64, v11, s[32:35], s59 offen
    v_cmp_eq_u32 vcc, 0, v124
    s_barrier
    s_lshl_b32 s45, s56, 11
    s_add_u32 m0, s52, 90112
    s_add_u32 s45, s45, s54
    buffer_load_dwordx4 v2, s[24:27], s45 offen sc1 lds
    buffer_load_dwordx4 v2, s[24:27], s45 offen offset:1024 sc1 lds
    s_add_u32 s56, s56, 1
    s_and_b32 s56, s56, 15
    s_lshl_b32 s45, s56, 11
    s_add_u32 m0, s52, 98304
    s_add_u32 s45, s45, s54
    buffer_load_dwordx4 v2, s[24:27], s45 offen sc1 lds
    buffer_load_dwordx4 v2, s[24:27], s45 offen offset:1024 sc1 lds
    s_add_u32 s56, s56, 1
    s_and_b32 s56, s56, 15
    s_lshl_b32 s45, s56, 11
    s_add_u32 m0, s52, 106496
    s_add_u32 s45, s45, s54
    buffer_load_dwordx4 v2, s[24:27], s45 offen sc1 lds
    buffer_load_dwordx4 v2, s[24:27], s45 offen offset:1024 sc1 lds
    s_add_u32 s56, s56, 1
    s_and_b32 s56, s56, 15
    s_waitcnt vmcnt(6)
    v_add_f32 v60, v60, v61
    v_add_f32 v62, v62, v63
    v_lshl_or_b32 v65, v64, 16, v64
    v_add_f32 v60, v60, v62
    v_mov_b32 v61, v60
    v_mov_b32 v71, 0
    v_cndmask_b32 v68, 0, v65, vcc
    v_permlane32_swap_b32 v60, v61
    s_nop 1
    v_add_f32 v60, v60, v61
    v_and_b32 v62, s50, v60
    v_sub_f32 v63, v60, v62
    v_cvt_pk_bf16_f32 v62, v62, v62
    v_cvt_pk_bf16_f32 v63, v63, 0
    v_cndmask_b32 v69, 0, v62, vcc
    v_cndmask_b32 v70, 0, v63, vcc
    ds_write_b128 v13, v[68:71]
    s_waitcnt vmcnt(4)
    s_barrier
    s_lshl_b32 s45, s56, 11
    s_add_u32 m0, s52, 114688
    s_add_u32 s45, s45, s54
    buffer_load_dwordx4 v2, s[24:27], s45 offen sc1 lds
    buffer_load_dwordx4 v2, s[24:27], s45 offen offset:1024 sc1 lds
    s_add_u32 s56, s56, 1
    s_and_b32 s56, s56, 15
    s_lshl_b32 s45, s56, 11
    s_add_u32 m0, s52, 122880
    s_add_u32 s45, s45, s54
    buffer_load_dwordx4 v2, s[24:27], s45 offen sc1 lds
    buffer_load_dwordx4 v2, s[24:27], s45 offen offset:1024 sc1 lds
    s_add_u32 s56, s56, 1
    s_and_b32 s56, s56, 15
    s_waitcnt vmcnt(6)
    s_barrier
    s_lshl_b32 s45, s56, 11
    s_add_u32 m0, s52, 131072
    s_add_u32 s45, s45, s54
    buffer_load_dwordx4 v2, s[24:27], s45 offen sc1 lds
    buffer_load_dwordx4 v2, s[24:27], s45 offen offset:1024 sc1 lds
    s_add_u32 s56, s56, 1
    s_and_b32 s56, s56, 15
    s_lshl_b32 s45, s56, 11
    s_add_u32 m0, s52, 139264
    s_add_u32 s45, s45, s54
    buffer_load_dwordx4 v2, s[24:27], s45 offen sc1 lds
    buffer_load_dwordx4 v2, s[24:27], s45 offen offset:1024 sc1 lds
    s_add_u32 s56, s56, 1
    s_and_b32 s56, s56, 15
    s_waitcnt vmcnt(6)
    s_barrier
    s_lshl_b32 s45, s56, 11
    s_add_u32 m0, s52, 0
    s_add_u32 s45, s45, s54
    buffer_load_dwordx4 v2, s[24:27], s45 offen sc1 lds
    buffer_load_dwordx4 v2, s[24:27], s45 offen offset:1024 sc1 lds
    s_add_u32 s56, s56, 1
    s_and_b32 s56, s56, 15
    s_mul_i32 s44, s55, 114688
    s_add_u32 m0, s51, 90112
    s_add_u32 s44, s44, s57
    buffer_load_dwordx4 v4, s[28:31], s44 offen lds
    s_add_u32 m0, s51, 94208
    s_add_u32 s44, s44, 128
    buffer_load_dwordx4 v4, s[28:31], s44 offen lds
    s_add_u32 s55, s55, 1
    s_and_b32 s55, s55, 15
    s_waitcnt vmcnt(6)
    s_barrier
    s_lshl_b32 s45, s56, 11
    s_add_u32 m0, s52, 8192
    s_add_u32 s45, s45, s54
    buffer_load_dwordx4 v2, s[24:27], s45 offen sc1 lds
    buffer_load_dwordx4 v2, s[24:27], s45 offen offset:1024 sc1 lds
    s_add_u32 s56, s56, 1
    s_and_b32 s56, s56, 15
    s_mul_i32 s44, s55, 114688
    s_add_u32 m0, s51, 98304
    s_add_u32 s44, s44, s57
    buffer_load_dwordx4 v4, s[28:31], s44 offen lds
    s_add_u32 m0, s51, 102400
    s_add_u32 s44, s44, 128
    buffer_load_dwordx4 v4, s[28:31], s44 offen lds
    s_add_u32 s55, s55, 1
    s_and_b32 s55, s55, 15
    s_lshl_b32 s45, s56, 11
    s_add_u32 m0, s52, 16384
    s_add_u32 s45, s45, s54
    buffer_load_dwordx4 v2, s[24:27], s45 offen sc1 lds
    buffer_load_dwordx4 v2, s[24:27], s45 offen offset:1024 sc1 lds
    s_add_u32 s56, s56, 1
    s_and_b32 s56, s56, 15
    s_mul_i32 s44, s55, 114688
    s_add_u32 m0, s51, 106496
    s_add_u32 s44, s44, s57
    buffer_load_dwordx4 v4, s[28:31], s44 offen lds
    s_add_u32 m0, s51, 110592
    s_add_u32 s44, s44, 128
    buffer_load_dwordx4 v4, s[28:31], s44 offen lds
    s_add_u32 s55, s55, 1
    s_and_b32 s55, s55, 15
    s_waitcnt vmcnt(10)
    s_barrier
    s_lshl_b32 s45, s56, 11
    s_add_u32 m0, s52, 24576
    s_add_u32 s45, s45, s54
    buffer_load_dwordx4 v2, s[24:27], s45 offen sc1 lds
    buffer_load_dwordx4 v2, s[24:27], s45 offen offset:1024 sc1 lds
    s_add_u32 s56, s56, 1
    s_and_b32 s56, s56, 15
    s_mul_i32 s44, s55, 114688
    s_add_u32 m0, s51, 114688
    s_add_u32 s44, s44, s57
    buffer_load_dwordx4 v4, s[28:31], s44 offen lds
    s_add_u32 m0, s51, 118784
    s_add_u32 s44, s44, 128
    buffer_load_dwordx4 v4, s[28:31], s44 offen lds
    s_add_u32 s55, s55, 1
    s_and_b32 s55, s55, 15
    s_lshl_b32 s45, s56, 11
    s_add_u32 m0, s52, 32768
    s_add_u32 s45, s45, s54
    buffer_load_dwordx4 v2, s[24:27], s45 offen sc1 lds
    buffer_load_dwordx4 v2, s[24:27], s45 offen offset:1024 sc1 lds
    s_add_u32 s56, s56, 1
    s_and_b32 s56, s56, 15
    s_mul_i32 s44, s55, 114688
    s_add_u32 m0, s51, 122880
    s_add_u32 s44, s44, s57
    buffer_load_dwordx4 v4, s[28:31], s44 offen lds
    s_add_u32 m0, s51, 126976
    s_add_u32 s44, s44, 128
    buffer_load_dwordx4 v4, s[28:31], s44 offen lds
    s_add_u32 s55, s55, 1
    s_and_b32 s55, s55, 15
    s_waitcnt vmcnt(10)
    s_barrier
    s_lshl_b32 s45, s56, 11
    s_add_u32 m0, s52, 40960
    s_add_u32 s45, s45, s54
    buffer_load_dwordx4 v2, s[24:27], s45 offen sc1 lds
    buffer_load_dwordx4 v2, s[24:27], s45 offen offset:1024 sc1 lds
    s_add_u32 s56, s56, 1
    s_and_b32 s56, s56, 15
    s_lshl_b32 s45, s56, 11
    s_add_u32 m0, s52, 131072
    s_add_u32 s45, s45, s54
    buffer_load_dwordx4 v2, s[24:27], s45 offen sc1 lds
    buffer_load_dwordx4 v2, s[24:27], s45 offen offset:1024 sc1 lds
    s_add_u32 s56, s56, 1
    s_and_b32 s56, s56, 15
    s_lshl_b32 s45, s56, 11
    s_add_u32 m0, s52, 49152
    s_add_u32 s45, s45, s54
    buffer_load_dwordx4 v2, s[24:27], s45 offen sc1 lds
    buffer_load_dwordx4 v2, s[24:27], s45 offen offset:1024 sc1 lds
    s_add_u32 s56, s56, 1
    s_and_b32 s56, s56, 15
    s_lshl_b32 s45, s56, 11
    s_add_u32 m0, s52, 139264
    s_add_u32 s45, s45, s54
    buffer_load_dwordx4 v2, s[24:27], s45 offen sc1 lds
    buffer_load_dwordx4 v2, s[24:27], s45 offen offset:1024 sc1 lds
    s_add_u32 s56, s56, 1
    s_and_b32 s56, s56, 15
    buffer_load_dwordx2 v[24:25], v12, s[24:27], s60 offen offset:0 sc1
    buffer_load_dwordx2 v[26:27], v12, s[24:27], s60 offen offset:256 sc1
    buffer_load_dwordx2 v[28:29], v12, s[24:27], s60 offen offset:512 sc1
    buffer_load_dwordx2 v[30:31], v12, s[24:27], s60 offen offset:768 sc1
    buffer_load_dwordx2 v[32:33], v12, s[24:27], s60 offen offset:1024 sc1
    buffer_load_dwordx2 v[34:35], v12, s[24:27], s60 offen offset:1280 sc1
    buffer_load_dwordx2 v[36:37], v12, s[24:27], s60 offen offset:1536 sc1
    buffer_load_dwordx2 v[38:39], v12, s[24:27], s60 offen offset:1792 sc1
    buffer_load_dwordx2 v[40:41], v12, s[24:27], s60 offen offset:2048 sc1
    buffer_load_dwordx2 v[42:43], v12, s[24:27], s60 offen offset:2304 sc1
    buffer_load_dwordx2 v[44:45], v12, s[24:27], s60 offen offset:2560 sc1
    buffer_load_dwordx2 v[46:47], v12, s[24:27], s60 offen offset:2816 sc1
    buffer_load_dwordx2 v[48:49], v12, s[24:27], s60 offen offset:3072 sc1
    buffer_load_dwordx2 v[50:51], v12, s[24:27], s60 offen offset:3328 sc1
    buffer_load_dwordx2 v[52:53], v12, s[24:27], s60 offen offset:3584 sc1
    buffer_load_dwordx2 v[54:55], v12, s[24:27], s60 offen offset:3840 sc1
    s_waitcnt vmcnt(26)
    s_barrier
    s_waitcnt vmcnt(20)
    s_barrier
    s_waitcnt vmcnt(0)
    v_add_f32 v24, v24, v40
    v_add_f32 v25, v25, v41
    v_add_f32 v26, v26, v42
    v_add_f32 v27, v27, v43
    v_add_f32 v28, v28, v44
    v_add_f32 v29, v29, v45
    v_add_f32 v30, v30, v46
    v_add_f32 v31, v31, v47
    v_add_f32 v32, v32, v48
    v_add_f32 v33, v33, v49
    v_add_f32 v34, v34, v50
    v_add_f32 v35, v35, v51
    v_add_f32 v36, v36, v52
    v_add_f32 v37, v37, v53
    v_add_f32 v38, v38, v54
    v_add_f32 v39, v39, v55
    v_add_f32 v24, v24, v32
    v_add_f32 v25, v25, v33
    v_add_f32 v26, v26, v34
    v_add_f32 v27, v27, v35
    v_add_f32 v28, v28, v36
    v_add_f32 v29, v29, v37
    v_add_f32 v30, v30, v38
    v_add_f32 v31, v31, v39
    v_add_f32 v24, v24, v26
    v_add_f32 v25, v25, v27
    v_add_f32 v28, v28, v30
    v_add_f32 v29, v29, v31
    v_add_f32 v24, v24, v28
    v_add_f32 v25, v25, v29
    v_mov_b32 v26, v24
    v_mov_b32 v27, v25
    s_nop 1
    v_permlane32_swap_b32 v24, v26
    v_permlane32_swap_b32 v25, v27
    s_nop 1
    v_add_f32 v24, v24, v26
    v_add_f32 v25, v25, v27
    v_mul_f32 v28, 0xbb000000, v24
    v_mul_f32 v29, 0x3b000000, v25
    v_fma_f32 v29, -v28, v28, v29
    v_max_f32 v29, 0, v29
    v_add_f32 v29, 0x3727c5ac, v29
    v_rsq_f32 v31, v29
    v_sqrt_f32 v30, v29
    v_and_b32 v25, s50, v28
    ds_write_b32 v14, v31
    v_and_b32 v24, s50, v30
    v_sub_f32 v26, v30, v24
    v_sub_f32 v27, v28, v25
    v_cvt_pk_bf16_f32 v72, v24, v26
    v_cvt_pk_bf16_f32 v73, v25, v27
    v_lshrrev_b32 v74, 16, v25
    v_mov_b32 v75, 0
    ds_write_b128 v13, v[72:75] offset:4096
    s_waitcnt vmcnt(16)
    s_waitcnt lgkmcnt(0)
    s_barrier
k2_main_kernel_ldr5:
    s_mov_b32 s28, s16
    s_mov_b32 s29, s17
    s_mov_b32 s30, 1835008
    s_mov_b32 s31, 0x00020000
    s_mul_i32 s47, s43, 7
    s_lshr_b32 s47, s47, 2
    s_mul_i32 s58, s49, 458752
    s_lshl_b32 s44, s40, 7
    s_add_u32 s58, s58, s44
    s_mul_i32 s59, s49, 38912
    s_mov_b32 s48, 0
    s_barrier
k2_main_kernel_r5a:
    s_lshl_b32 s44, s47, 15
    s_add_u32 s44, s44, s58
    s_add_u32 m0, s59, s48
    s_add_u32 s45, s44, 7168
    buffer_load_dwordx4 v15, s[28:31], s44 offen lds
    buffer_load_dwordx4 v15, s[28:31], s45 offen offset:1024 lds
    s_add_u32 s47, s47, 1
    s_cmp_eq_u32 s47, 14
    s_cselect_b32 s47, 0, s47
    s_add_u32 s48, s48, 2048
    s_waitcnt vmcnt(2)
    s_cmp_lt_u32 s48, 16384
    s_cbranch_scc1 k2_main_kernel_r5a
k2_main_kernel_r5h:
    s_lshl_b32 s44, s47, 15
    s_add_u32 s44, s44, s58
    s_add_u32 m0, s59, s48
    s_add_u32 s45, s44, 7168
    buffer_load_dwordx4 v15, s[28:31], s44 offen lds
    buffer_load_dwordx4 v15, s[28:31], s45 offen offset:1024 lds
    s_add_u32 s47, s47, 1
    s_cmp_eq_u32 s47, 14
    s_cselect_b32 s47, 0, s47
    s_add_u32 s48, s48, 2048
    s_waitcnt vmcnt(6)
    s_cmp_lt_u32 s48, 28672
    s_cbranch_scc1 k2_main_kernel_r5h
    s_add_u32 s58, s58, 16384
k2_main_kernel_r5b:
    s_lshl_b32 s44, s47, 15
    s_add_u32 s44, s44, s58
    s_add_u32 m0, s59, s48
    s_add_u32 s45, s44, 7168
    buffer_load_dwordx4 v15, s[28:31], s44 offen lds
    buffer_load_dwordx4 v15, s[28:31], s45 offen offset:1024 lds
    s_add_u32 s47, s47, 1
    s_cmp_eq_u32 s47, 14
    s_cselect_b32 s47, 0, s47
    s_add_u32 s48, s48, 2048
    s_waitcnt vmcnt(6)
    s_cmp_lt_u32 s48, 38912
    s_cbranch_scc1 k2_main_kernel_r5b
    s_waitcnt vmcnt(0)
    s_barrier
    s_mov_b32 s48, 0
    s_barrier
k2_main_kernel_r5c:
    s_lshl_b32 s44, s47, 15
    s_add_u32 s44, s44, s58
    s_add_u32 m0, s59, s48
    s_add_u32 s45, s44, 7168
    buffer_load_dwordx4 v15, s[28:31], s44 offen lds
    buffer_load_dwordx4 v15, s[28:31], s45 offen offset:1024 lds
    s_add_u32 s47, s47, 1
    s_cmp_eq_u32 s47, 14
    s_cselect_b32 s47, 0, s47
    s_add_u32 s48, s48, 2048
    s_cmp_lt_u32 s48, 10240
    s_cbranch_scc1 k2_main_kernel_r5c
    s_cmp_lg_u32 s49, 3
    s_cbranch_scc1 k2_main_kernel_np4b
    v_lshlrev_b32 v3, 1, v0
    s_bfe_u32 s44, s38, 0x10001
    v_add_u32 v3, s44, v3
    v_lshlrev_b32 v3, 3, v3
    v_add_u32 v3, s37, v3
    v_lshlrev_b32 v3, 7, v3
    s_mov_b32 exec_lo, 0x3fff
    s_mov_b32 exec_hi, 0
    s_mov_b32 s45, 262144
    s_mov_b32 s44, 18907140
    s_mov_b32 s46, 18972676
    s_mov_b64 s[62:63], -1
k2_main_kernel_pl4b:
    buffer_load_dword v88, v3, s[24:27], s46 offen sc1
    s_waitcnt vmcnt(0)
    v_cmp_ne_u32 vcc, 1, v88
    s_nop 3
    s_and_b64 vcc, vcc, s[62:63]
    s_cbranch_scc0 k2_main_kernel_pd4b
    buffer_load_dword v88, v3, s[24:27], s46 offen sc1
    s_waitcnt vmcnt(0)
    v_cmp_ne_u32 vcc, 1, v88
    s_nop 3
    s_and_b64 vcc, vcc, s[62:63]
    s_cbranch_scc0 k2_main_kernel_pd4b
    buffer_load_dword v88, v3, s[24:27], s46 offen sc1
    s_waitcnt vmcnt(0)
    v_cmp_ne_u32 vcc, 1, v88
    s_nop 3
    s_and_b64 vcc, vcc, s[62:63]
    s_cbranch_scc0 k2_main_kernel_pd4b
    buffer_load_dword v88, v3, s[24:27], s46 offen sc1
    s_waitcnt vmcnt(0)
    v_cmp_ne_u32 vcc, 1, v88
    s_nop 3
    s_and_b64 vcc, vcc, s[62:63]
    s_cbranch_scc0 k2_main_kernel_pd4b
    buffer_load_dword v88, v3, s[24:27], s46 offen sc1
    s_waitcnt vmcnt(0)
    v_cmp_ne_u32 vcc, 1, v88
    s_nop 3
    s_and_b64 vcc, vcc, s[62:63]
    s_cbranch_scc0 k2_main_kernel_pd4b
    buffer_load_dword v88, v3, s[24:27], s46 offen sc1
    s_waitcnt vmcnt(0)
    v_cmp_ne_u32 vcc, 1, v88
    s_nop 3
    s_and_b64 vcc, vcc, s[62:63]
    s_cbranch_scc0 k2_main_kernel_pd4b
    buffer_load_dword v88, v3, s[24:27], s46 offen sc1
    s_waitcnt vmcnt(0)
    v_cmp_ne_u32 vcc, 1, v88
    s_nop 3
    s_and_b64 vcc, vcc, s[62:63]
    s_cbranch_scc0 k2_main_kernel_pd4b
    buffer_load_dword v88, v3, s[24:27], s46 offen sc1
    s_waitcnt vmcnt(0)
    v_cmp_ne_u32 vcc, 1, v88
    s_nop 3
    s_and_b64 vcc, vcc, s[62:63]
    s_cbranch_scc0 k2_main_kernel_pd4b
    buffer_load_dword v89, v3, s[24:27], s44 offen sc1
    s_sub_u32 s45, s45, 1
    s_waitcnt vmcnt(0)
    v_cmp_ne_u32 vcc, 1, v89
    s_cmp_eq_u32 s45, 0
    s_cbranch_scc1 k2_main_kernel_pd4b
    s_nop 2
    s_and_b64 s[62:63], vcc, exec
    s_cbranch_scc1 k2_main_kernel_pl4b
k2_main_kernel_pd4b:
    s_mov_b64 exec, -1
k2_main_kernel_np4b:
    s_barrier
k2_main_kernel_r5d:
    s_lshl_b32 s44, s47, 15
    s_add_u32 s44, s44, s58
    s_add_u32 m0, s59, s48
    s_add_u32 s45, s44, 7168
    buffer_load_dwordx4 v15, s[28:31], s44 offen lds
    buffer_load_dwordx4 v15, s[28:31], s45 offen offset:1024 lds
    s_add_u32 s47, s47, 1
    s_cmp_eq_u32 s47, 14
    s_cselect_b32 s47, 0, s47
    s_add_u32 s48, s48, 2048
    s_cmp_lt_u32 s48, 18432
    s_cbranch_scc1 k2_main_kernel_r5d
    s_waitcnt vmcnt(0)
    s_barrier
k2_main_kernel_end:
    s_endpgm

.section .rodata,"a"
.p2align 6
.amdhsa_kernel k1_qkv_kernel
  .amdhsa_next_free_vgpr 128
  .amdhsa_next_free_sgpr 96
  .amdhsa_accum_offset 128
  .amdhsa_group_segment_fixed_size 0
  .amdhsa_kernarg_size 80
  .amdhsa_user_sgpr_count 2
  .amdhsa_user_sgpr_kernarg_segment_ptr 1
  .amdhsa_system_sgpr_workgroup_id_x 1
.end_amdhsa_kernel

.p2align 6
.amdhsa_kernel k2_main_kernel
  .amdhsa_next_free_vgpr 128
  .amdhsa_next_free_sgpr 96
  .amdhsa_accum_offset 128
  .amdhsa_group_segment_fixed_size 0
  .amdhsa_kernarg_size 80
  .amdhsa_user_sgpr_count 2
  .amdhsa_user_sgpr_kernarg_segment_ptr 1
  .amdhsa_system_sgpr_workgroup_id_x 1
.end_amdhsa_kernel
```
